```python
import torch

def _softmax(x, axis=-1):
    return torch.softmax(x, dim=axis)
def _gelu(x):
    return torch.nn.functional.gelu(x, approximate="tanh")
def _silu(x):
    return torch.nn.functional.silu(x)
def _sigmoid(x):
    return torch.sigmoid(x)
def _layernorm(x, axis=-1, eps=1e-5):
    m = x.mean(dim=axis, keepdim=True)
    v = x.var(dim=axis, keepdim=True, unbiased=False)
    return (x - m) / torch.sqrt(v + eps)
def _scatter_add(tgt, idx, src, axis=0):
    return tgt.clone().index_add_(axis, idx, src)
def _segment_sum(src, seg, n):
    out = torch.zeros((n,) + src.shape[1:], dtype=src.dtype)
    return out.index_add_(0, seg, src)
def _pad(x, pw):
    flat = tuple(v for pair in reversed(pw) for v in pair)
    return torch.nn.functional.pad(x, flat)

kernel_name = 'sequential_preLN__sliding_local_dilated__glu_gated_bilinear__prompt'

def setup_inputs():

    _w = (lambda a: (lambda t: t.to(torch.bfloat16) if t.is_floating_point() else t)(torch.as_tensor(a)))
    def _A_setup():
        B, S, D = 1, 2048, 640
        return {
            "x": _w((lambda *s: torch.randn(*s, dtype=torch.bfloat16) * 0.05)(B, S, D)),
            "wqkv": _w((lambda *s: torch.randn(*s, dtype=torch.bfloat16) * 0.05)(D, 3 * D)),
            "wo": _w((lambda *s: torch.randn(*s, dtype=torch.bfloat16) * 0.05)(D, D)),
        }
    _A_in = _A_setup()

    def _B_setup():
        B, S, D, F = 1, 2048, 640, 1728
        return {
            "x": _w((lambda *s: torch.randn(*s, dtype=torch.bfloat16) * 0.05)(B, S, D)),
            "w_gate": _w((lambda *s: torch.randn(*s, dtype=torch.bfloat16) * 0.8)(D, F) * (D ** -0.5)),
            "w_up": _w((lambda *s: torch.randn(*s, dtype=torch.bfloat16) * 0.8)(D, F) * (D ** -0.5)),
            "w_down": _w((lambda *s: torch.randn(*s, dtype=torch.bfloat16) * 0.8)(F, D) * (F ** -0.5)),
        }
    _B_in = _B_setup()

    return {
        "A_x": _A_in["x"],
        "A_wqkv": _A_in["wqkv"],
        "A_wo": _A_in["wo"],
        "B_x": _B_in["x"],
        "B_w_gate": _B_in["w_gate"],
        "B_w_up": _B_in["w_up"],
        "B_w_down": _B_in["w_down"],
    }

def reference(A_x, A_wqkv, A_wo, B_x, B_w_gate, B_w_up, B_w_down):
    def _A_ref(x, wqkv, wo):
        B, S, D = x.shape
        H = 32; Dh = D // H
        W, dil = 8, 2
        qkv = (lambda x, *d: x.permute(*d))((x @ wqkv).reshape(B, S, 3, H, Dh), 2, 0, 3, 1, 4)
        q, k, v = qkv[0], qkv[1], qkv[2]
        scale = Dh ** -0.5
        pos = torch.arange(S)
        off = torch.arange(W) * dil
        idx = pos[:, None] - off[None, :]
        mask = idx >= 0
        idx_c = torch.where(mask, idx, 0).reshape(-1)
        kg = k[:, :, idx_c, :].reshape(B, H, S, W, Dh)
        vg = v[:, :, idx_c, :].reshape(B, H, S, W, Dh)
        logits = torch.einsum("bhsd,bhswd->bhsw", q, kg) * scale
        logits = torch.where(mask[None, None, :, :], logits, -1e9)
        attn = _softmax(logits, axis=-1)
        o = torch.einsum("bhsw,bhswd->bhsd", attn, vg)
        return (lambda x, *d: x.permute(*d))(o, 0, 2, 1, 3).reshape(B, S, D) @ wo

    def _B_ref(x, w_gate, w_up, w_down):
        g = torch.einsum("bsd,df->bsf", x, w_gate)
        u = torch.einsum("bsd,df->bsf", x, w_up)
        h = g * u
        return torch.einsum("bsf,fd->bsd", h, w_down)

    x = A_x
    h = x + _A_ref(_layernorm(x, axis=-1), A_wqkv, A_wo)
    h2 = h + _B_ref(_layernorm(h, axis=-1), B_w_gate, B_w_up, B_w_down)
    return h2
```

```asm
; @launch grid=(256,1,1) block=(512,1,1) lds=163840
.amdgcn_target "amdgcn-amd-amdhsa--gfx950"
.text
.globl sequential_preLN__sliding_local_dilated__glu_gated_bilinear__prompt_kernel
.p2align 8
.type sequential_preLN__sliding_local_dilated__glu_gated_bilinear__prompt_kernel,@function
sequential_preLN__sliding_local_dilated__glu_gated_bilinear__prompt_kernel:
  s_cmp_ge_u32 s2, 256
  s_cbranch_scc1 L_exit
  s_load_dwordx16 s[44:59], s[0:1], 0
  s_load_dwordx4 s[60:63], s[0:1], 64
  v_lshrrev_b32 v1, 6, v0
  v_and_b32 v2, 63, v0
  s_mov_b32 s85, -1
  s_mov_b32 s3, 0
  v_readfirstlane_b32 s36, v1
  s_nop 3
  s_sub_u32 s96, s36, 4
  s_cmp_ge_u32 s36, 4
  s_cbranch_scc1 L_loader
  s_and_b32 s39, s2, 7
  s_lshr_b32 s40, s2, 3
  s_lshl_b32 s39, s39, 5
  s_add_u32 s39, s39, s40
  s_cmp_lt_u32 s39, 256
  s_cselect_b32 s87, 1, 0
  s_lshr_b32 s40, s39, 6
  s_lshl_b32 s32, s40, 3
  s_bfe_u32 s41, s39, 196610
  s_add_u32 s32, s32, s41
  s_bfe_u32 s40, s39, 65541
  s_lshl_b32 s40, s40, 2
  s_and_b32 s33, s39, 3
  s_add_u32 s33, s33, s40
  s_cmp_eq_u32 s87, 0
  s_cbranch_scc1 Linv_2
  s_lshl_b32 s34, s32, 6
  s_sub_u32 s34, s34, 14
  s_mul_i32 s35, s33, 160
  v_and_b32 v3, 15, v2
  v_lshrrev_b32 v4, 4, v2
  v_lshrrev_b32 v5, 1, v3
  v_xor_b32 v5, v4, v5
  v_lshlrev_b32 v5, 4, v5
  v_lshl_add_u32 v8, v3, 7, v5
  v_lshrrev_b32 v5, 2, v3
  v_lshl_add_u32 v5, v4, 3, v5
  v_mul_u32_u24 v5, 160, v5
  v_and_b32 v6, 3, v3
  v_lshl_add_u32 v5, v6, 3, v5
  s_lshl_b32 s39, s36, 2
  s_add_u32 s39, s39, 0
  s_min_u32 s39, s39, 14
  s_mul_i32 s40, s39, 13108
  s_lshr_b32 s40, s40, 16
  s_mul_i32 s41, s40, 5
  s_sub_u32 s41, s39, s41
  s_lshl_b32 s41, s41, 5
  s_mul_i32 s94, s40, 10240
  s_add_u32 s94, s94, s41
  s_add_u32 s94, s94, 10240
  v_add_u32 v11, s94, v5
  s_mul_i32 s94, s40, 160
  s_add_u32 s94, s94, s41
  s_add_u32 s94, s94, 40960
  v_mul_u32_u24 v6, 488, v3
  v_lshl_add_u32 v6, v4, 3, v6
  v_add_u32 v20, s94, v6
  s_lshl_b32 s39, s36, 2
  s_add_u32 s39, s39, 1
  s_min_u32 s39, s39, 14
  s_mul_i32 s40, s39, 13108
  s_lshr_b32 s40, s40, 16
  s_mul_i32 s41, s40, 5
  s_sub_u32 s41, s39, s41
  s_lshl_b32 s41, s41, 5
  s_mul_i32 s94, s40, 10240
  s_add_u32 s94, s94, s41
  s_add_u32 s94, s94, 10240
  v_add_u32 v12, s94, v5
  s_mul_i32 s94, s40, 160
  s_add_u32 s94, s94, s41
  s_add_u32 s94, s94, 40960
  v_mul_u32_u24 v6, 488, v3
  v_lshl_add_u32 v6, v4, 3, v6
  v_add_u32 v21, s94, v6
  s_lshl_b32 s39, s36, 2
  s_add_u32 s39, s39, 2
  s_min_u32 s39, s39, 14
  s_mul_i32 s40, s39, 13108
  s_lshr_b32 s40, s40, 16
  s_mul_i32 s41, s40, 5
  s_sub_u32 s41, s39, s41
  s_lshl_b32 s41, s41, 5
  s_mul_i32 s94, s40, 10240
  s_add_u32 s94, s94, s41
  s_add_u32 s94, s94, 10240
  v_add_u32 v13, s94, v5
  s_mul_i32 s94, s40, 160
  s_add_u32 s94, s94, s41
  s_add_u32 s94, s94, 40960
  v_mul_u32_u24 v6, 488, v3
  v_lshl_add_u32 v6, v4, 3, v6
  v_add_u32 v22, s94, v6
  s_lshl_b32 s39, s36, 2
  s_add_u32 s39, s39, 3
  s_min_u32 s39, s39, 14
  s_mul_i32 s40, s39, 13108
  s_lshr_b32 s40, s40, 16
  s_mul_i32 s41, s40, 5
  s_sub_u32 s41, s39, s41
  s_lshl_b32 s41, s41, 5
  s_mul_i32 s94, s40, 10240
  s_add_u32 s94, s94, s41
  s_add_u32 s94, s94, 10240
  v_add_u32 v14, s94, v5
  s_mul_i32 s94, s40, 160
  s_add_u32 s94, s94, s41
  s_add_u32 s94, s94, 40960
  v_mul_u32_u24 v6, 488, v3
  v_lshl_add_u32 v6, v4, 3, v6
  v_add_u32 v23, s94, v6
  v_lshlrev_b32 v25, 3, v3
  v_add_u32 v25, 122880, v25
  s_mul_i32 s39, s36, 640
  v_add_u32 v24, s39, v25
  s_mov_b32 s6, 0
  v_lshrrev_b32 v5, 3, v2
  v_and_b32 v6, 7, v2
  s_lshl_b32 s39, s36, 3
  v_add_u32 v7, s39, v5
  v_mul_u32_u24 v26, 176, v7
  v_lshl_add_u32 v26, v6, 4, v26
  v_add_u32 v26, 81920, v26
  s_add_u32 s39, s34, 14
  v_add_u32 v28, s39, v7
  v_lshlrev_b32 v28, 10, v28
  v_lshl_add_u32 v28, v6, 4, v28
  s_lshl_b32 s40, s33, 7
  v_add_u32 v28, s40, v28
  v_lshrrev_b32 v5, 1, v6
  v_lshl_add_u32 v5, v7, 2, v5
  v_mul_u32_u24 v27, 176, v5
  v_and_b32 v5, 1, v6
  v_lshl_add_u32 v27, v5, 4, v27
  v_add_u32 v27, 82048, v27
  s_lshr_b32 s39, s39, 2
  v_add_u32 v29, s39, v7
  v_lshlrev_b32 v29, 10, v29
  v_lshl_add_u32 v29, v6, 4, v29
  s_add_u32 s40, s40, 0x200000
  v_add_u32 v29, s40, v29
  s_mov_b32 s37, 0
  v_add_u32 v9, s37, v8
  v_add_u32 v15, s37, v11
  v_add_u32 v16, s37, v12
  v_add_u32 v17, s37, v13
  v_add_u32 v18, s37, v14
  v_xor_b32 v10, 64, v9
  s_waitcnt lgkmcnt(0)
  s_add_u32 s88, s62, 0x1900000
  s_addc_u32 s89, s63, 0
  s_and_b32 s89, s89, 0xffff
  s_mov_b32 s90, 0x20000
  s_mov_b32 s91, 0x20000
  s_add_u32 s20, s62, 0x800000
  s_addc_u32 s21, s63, 0
  s_and_b32 s21, s21, 0xffff
  s_mov_b32 s22, 0x280000
  s_mov_b32 s23, 0x20000
  s_cmp_eq_u32 s36, 0
  s_cbranch_scc0 Lnonce_3
  s_cmp_eq_u32 s2, 0
  s_cbranch_scc0 Lnonce_3
  s_mov_b32 s80, s60
  s_and_b32 s81, s61, 0xffff
  s_mov_b32 s82, 0x100
  s_mov_b32 s83, 0x20000
  s_memrealtime s[78:79]
  v_mov_b32 v5, 0
  s_waitcnt lgkmcnt(0)
  s_or_b32 s78, s78, 1
  v_mov_b32 v6, s78
  v_mov_b32 v7, s79
  s_mov_b64 exec, 1
  buffer_store_dwordx2 v[6:7], v5, s[80:83], 0 offen sc1
  s_mov_b64 exec, -1
Lnonce_3:
  s_mov_b32 s24, s44
  s_mov_b32 s25, s45
  s_and_b32 s25, s25, 0xffff
  s_mov_b32 s26, 0x280000
  s_mov_b32 s27, 0x20000
  s_add_u32 s28, s62, 0x1880000
  s_addc_u32 s29, s63, 0
  s_and_b32 s29, s29, 0xffff
  s_mov_b32 s30, 0x8000
  s_mov_b32 s31, 0x20000
  s_lshl_b32 s39, s32, 6
  s_lshl_b32 s40, s33, 3
  s_add_u32 s39, s39, s40
  s_lshl_b32 s40, s36, 1
  s_add_u32 s39, s39, s40
  v_lshrrev_b32 v5, 5, v2
  v_add_u32 v5, s39, v5
  v_and_b32 v6, 31, v2
  v_mul_u32_u24 v7, 1280, v5
  v_lshl_add_u32 v7, v6, 4, v7
  v_mov_b32 v30, 0x80000000
  v_cmp_gt_u32 vcc, 16, v6
  v_add_u32 v31, 1024, v7
  buffer_load_dwordx4 v[32:35], v7, s[24:27], 0 offen
  v_cndmask_b32 v31, v30, v31, vcc
  buffer_load_dwordx4 v[36:39], v7, s[24:27], 0 offen offset:512
  buffer_load_dwordx4 v[40:43], v31, s[24:27], 0 offen
  s_waitcnt vmcnt(0)
  v_mov_b32 v48, 0x3f803f80
  v_mov_b32 v49, 0
  v_mov_b32 v50, 0
  v_mov_b32 v51, 0
  v_mov_b32 v52, 0
  v_dot2_f32_bf16 v49, v32, v48, v49
  v_dot2_f32_bf16 v50, v32, v32, v50
  v_dot2_f32_bf16 v51, v33, v48, v51
  v_dot2_f32_bf16 v52, v33, v33, v52
  v_dot2_f32_bf16 v49, v34, v48, v49
  v_dot2_f32_bf16 v50, v34, v34, v50
  v_dot2_f32_bf16 v51, v35, v48, v51
  v_dot2_f32_bf16 v52, v35, v35, v52
  v_dot2_f32_bf16 v49, v36, v48, v49
  v_dot2_f32_bf16 v50, v36, v36, v50
  v_dot2_f32_bf16 v51, v37, v48, v51
  v_dot2_f32_bf16 v52, v37, v37, v52
  v_dot2_f32_bf16 v49, v38, v48, v49
  v_dot2_f32_bf16 v50, v38, v38, v50
  v_dot2_f32_bf16 v51, v39, v48, v51
  v_dot2_f32_bf16 v52, v39, v39, v52
  v_dot2_f32_bf16 v49, v40, v48, v49
  v_dot2_f32_bf16 v50, v40, v40, v50
  v_dot2_f32_bf16 v51, v41, v48, v51
  v_dot2_f32_bf16 v52, v41, v41, v52
  v_dot2_f32_bf16 v49, v42, v48, v49
  v_dot2_f32_bf16 v50, v42, v42, v50
  v_dot2_f32_bf16 v51, v43, v48, v51
  v_dot2_f32_bf16 v52, v43, v43, v52
  s_nop 2
  v_add_f32 v44, v49, v51
  v_add_f32 v45, v50, v52
  s_nop 1
  v_add_f32_dpp v44, v44, v44 quad_perm:[1,0,3,2] row_mask:0xf bank_mask:0xf
  v_add_f32_dpp v45, v45, v45 quad_perm:[1,0,3,2] row_mask:0xf bank_mask:0xf
  s_nop 0
  v_add_f32_dpp v44, v44, v44 quad_perm:[2,3,0,1] row_mask:0xf bank_mask:0xf
  v_add_f32_dpp v45, v45, v45 quad_perm:[2,3,0,1] row_mask:0xf bank_mask:0xf
  s_nop 0
  v_add_f32_dpp v44, v44, v44 row_half_mirror row_mask:0xf bank_mask:0xf
  v_add_f32_dpp v45, v45, v45 row_half_mirror row_mask:0xf bank_mask:0xf
  s_nop 0
  v_add_f32_dpp v44, v44, v44 row_mirror row_mask:0xf bank_mask:0xf
  v_add_f32_dpp v45, v45, v45 row_mirror row_mask:0xf bank_mask:0xf
  s_nop 0
  v_mov_b32 v49, v44
  v_mov_b32 v50, v45
  s_nop 1
  v_permlane16_swap_b32 v44, v49
  v_permlane16_swap_b32 v45, v50
  s_nop 1
  v_add_f32 v44, v44, v49
  v_add_f32 v45, v45, v50
  v_mul_f32 v44, 0x3acccccd, v44
  v_mul_f32 v45, 0x3acccccd, v45
  v_fma_f32 v45, -v44, v44, v45
  v_add_f32 v45, 0x3727c5ac, v45
  v_rsq_f32 v45, v45
  v_mov_b32 v112, v44
  v_mov_b32 v113, v45
  v_lshlrev_b32 v116, 4, v5
  v_mov_b32 v117, 0
  s_mov_b32 s80, s60
  s_and_b32 s81, s61, 0xffff
  s_mov_b32 s82, 0x100
  s_mov_b32 s83, 0x20000
  s_barrier
  buffer_load_dwordx2 v[114:115], v117, s[80:83], 0 offen sc1
  ds_read_b64_tr_b16 a[40:41], v15 offset:0
  ds_read_b64_tr_b16 a[42:43], v15 offset:640
  ds_read_b64_tr_b16 a[44:45], v16 offset:0
  ds_read_b64_tr_b16 a[46:47], v16 offset:640
  ds_read_b64_tr_b16 a[48:49], v17 offset:0
  ds_read_b64_tr_b16 a[50:51], v17 offset:640
  ds_read_b64_tr_b16 a[52:53], v18 offset:0
  ds_read_b64_tr_b16 a[54:55], v18 offset:640
  ds_read_b128 a[0:3], v9 offset:0
  ds_read_b128 a[4:7], v9 offset:2048
  ds_read_b128 a[8:11], v9 offset:4096
  ds_read_b128 a[12:15], v9 offset:6144
  ds_read_b128 a[16:19], v9 offset:8192
  s_mov_b32 s38, 9
  s_waitcnt lgkmcnt(0)
  v_mfma_f32_16x16x32_bf16 v[32:35], a[40:43], a[0:3], 0
  ds_read_b64_tr_b16 a[56:57], v15 offset:5120
  v_mfma_f32_16x16x32_bf16 v[36:39], a[44:47], a[0:3], 0
  ds_read_b64_tr_b16 a[58:59], v15 offset:5760
  v_mfma_f32_16x16x32_bf16 v[40:43], a[48:51], a[0:3], 0
  ds_read_b64_tr_b16 a[60:61], v16 offset:5120
  v_mfma_f32_16x16x32_bf16 v[44:47], a[52:55], a[0:3], 0
  ds_read_b64_tr_b16 a[62:63], v16 offset:5760
  v_mfma_f32_16x16x32_bf16 v[48:51], a[40:43], a[4:7], 0
  ds_read_b64_tr_b16 a[64:65], v17 offset:5120
  v_mfma_f32_16x16x32_bf16 v[52:55], a[44:47], a[4:7], 0
  ds_read_b64_tr_b16 a[66:67], v17 offset:5760
  v_mfma_f32_16x16x32_bf16 v[56:59], a[48:51], a[4:7], 0
  ds_read_b64_tr_b16 a[68:69], v18 offset:5120
  v_mfma_f32_16x16x32_bf16 v[60:63], a[52:55], a[4:7], 0
  ds_read_b64_tr_b16 a[70:71], v18 offset:5760
  v_mfma_f32_16x16x32_bf16 v[64:67], a[40:43], a[8:11], 0
  ds_read_b128 a[20:23], v10 offset:0
  v_mfma_f32_16x16x32_bf16 v[68:71], a[44:47], a[8:11], 0
  ds_read_b128 a[24:27], v10 offset:2048
  v_mfma_f32_16x16x32_bf16 v[72:75], a[48:51], a[8:11], 0
  ds_read_b128 a[28:31], v10 offset:4096
  v_mfma_f32_16x16x32_bf16 v[76:79], a[52:55], a[8:11], 0
  ds_read_b128 a[32:35], v10 offset:6144
  v_mfma_f32_16x16x32_bf16 v[80:83], a[40:43], a[12:15], 0
  ds_read_b128 a[36:39], v10 offset:8192
  s_add_u32 s37, s37, 40960
  v_mfma_f32_16x16x32_bf16 v[84:87], a[44:47], a[12:15], 0
  s_cmp_ge_u32 s37, 122880
  s_cselect_b32 s37, 0, s37
  v_mfma_f32_16x16x32_bf16 v[88:91], a[48:51], a[12:15], 0
  v_add_u32 v9, s37, v8
  v_add_u32 v15, s37, v11
  v_mfma_f32_16x16x32_bf16 v[92:95], a[52:55], a[12:15], 0
  v_add_u32 v16, s37, v12
  v_add_u32 v17, s37, v13
  v_mfma_f32_16x16x32_bf16 v[96:99], a[40:43], a[16:19], 0
  v_add_u32 v18, s37, v14
  v_xor_b32 v10, 64, v9
  v_mfma_f32_16x16x32_bf16 v[100:103], a[44:47], a[16:19], 0
  v_mfma_f32_16x16x32_bf16 v[104:107], a[48:51], a[16:19], 0
  v_mfma_f32_16x16x32_bf16 v[108:111], a[52:55], a[16:19], 0
  s_mov_b32 s39, 0x40000
  s_branch Lp0h_6
Lp0n_4:
  s_sleep 4
  buffer_load_dwordx2 v[114:115], v117, s[80:83], 0 offen sc1
Lp0h_6:
  s_waitcnt vmcnt(0)
  v_readfirstlane_b32 s78, v114
  v_readfirstlane_b32 s79, v115
  s_nop 3
  s_cmp_lg_u32 s78, 0
  s_cbranch_scc1 Lp0d_5
  s_sub_u32 s39, s39, 1
  s_cmp_lg_u32 s39, 0
  s_cbranch_scc1 Lp0n_4
Lp0d_5:
  s_mov_b32 exec_lo, 0x1
  s_mov_b32 exec_hi, 0x1
  buffer_store_dwordx4 v[112:115], v116, s[28:31], 0 offen sc1
  s_mov_b64 exec, -1
.p2align 6
Lcloop_7:
  s_waitcnt lgkmcnt(0)
  s_barrier
  v_mfma_f32_16x16x32_bf16 v[32:35], a[56:59], a[20:23], v[32:35]
  ds_read_b64_tr_b16 a[40:41], v15 offset:0
  v_mfma_f32_16x16x32_bf16 v[36:39], a[60:63], a[20:23], v[36:39]
  ds_read_b64_tr_b16 a[42:43], v15 offset:640
  v_mfma_f32_16x16x32_bf16 v[40:43], a[64:67], a[20:23], v[40:43]
  ds_read_b64_tr_b16 a[44:45], v16 offset:0
  v_mfma_f32_16x16x32_bf16 v[44:47], a[68:71], a[20:23], v[44:47]
  ds_read_b64_tr_b16 a[46:47], v16 offset:640
  v_mfma_f32_16x16x32_bf16 v[48:51], a[56:59], a[24:27], v[48:51]
  ds_read_b64_tr_b16 a[48:49], v17 offset:0
  v_mfma_f32_16x16x32_bf16 v[52:55], a[60:63], a[24:27], v[52:55]
  ds_read_b64_tr_b16 a[50:51], v17 offset:640
  v_mfma_f32_16x16x32_bf16 v[56:59], a[64:67], a[24:27], v[56:59]
  ds_read_b64_tr_b16 a[52:53], v18 offset:0
  v_mfma_f32_16x16x32_bf16 v[60:63], a[68:71], a[24:27], v[60:63]
  ds_read_b64_tr_b16 a[54:55], v18 offset:640
  v_mfma_f32_16x16x32_bf16 v[64:67], a[56:59], a[28:31], v[64:67]
  ds_read_b128 a[0:3], v9 offset:0
  v_mfma_f32_16x16x32_bf16 v[68:71], a[60:63], a[28:31], v[68:71]
  ds_read_b128 a[4:7], v9 offset:2048
  v_mfma_f32_16x16x32_bf16 v[72:75], a[64:67], a[28:31], v[72:75]
  ds_read_b128 a[8:11], v9 offset:4096
  v_mfma_f32_16x16x32_bf16 v[76:79], a[68:71], a[28:31], v[76:79]
  ds_read_b128 a[12:15], v9 offset:6144
  v_mfma_f32_16x16x32_bf16 v[80:83], a[56:59], a[32:35], v[80:83]
  ds_read_b128 a[16:19], v9 offset:8192
  s_sub_u32 s38, s38, 1
  v_mfma_f32_16x16x32_bf16 v[84:87], a[60:63], a[32:35], v[84:87]
  v_mfma_f32_16x16x32_bf16 v[88:91], a[64:67], a[32:35], v[88:91]
  v_mfma_f32_16x16x32_bf16 v[92:95], a[68:71], a[32:35], v[92:95]
  v_mfma_f32_16x16x32_bf16 v[96:99], a[56:59], a[36:39], v[96:99]
  v_mfma_f32_16x16x32_bf16 v[100:103], a[60:63], a[36:39], v[100:103]
  v_mfma_f32_16x16x32_bf16 v[104:107], a[64:67], a[36:39], v[104:107]
  v_mfma_f32_16x16x32_bf16 v[108:111], a[68:71], a[36:39], v[108:111]
  s_waitcnt lgkmcnt(0)
  v_mfma_f32_16x16x32_bf16 v[32:35], a[40:43], a[0:3], v[32:35]
  ds_read_b64_tr_b16 a[56:57], v15 offset:5120
  v_mfma_f32_16x16x32_bf16 v[36:39], a[44:47], a[0:3], v[36:39]
  ds_read_b64_tr_b16 a[58:59], v15 offset:5760
  v_mfma_f32_16x16x32_bf16 v[40:43], a[48:51], a[0:3], v[40:43]
  ds_read_b64_tr_b16 a[60:61], v16 offset:5120
  v_mfma_f32_16x16x32_bf16 v[44:47], a[52:55], a[0:3], v[44:47]
  ds_read_b64_tr_b16 a[62:63], v16 offset:5760
  v_mfma_f32_16x16x32_bf16 v[48:51], a[40:43], a[4:7], v[48:51]
  ds_read_b64_tr_b16 a[64:65], v17 offset:5120
  v_mfma_f32_16x16x32_bf16 v[52:55], a[44:47], a[4:7], v[52:55]
  ds_read_b64_tr_b16 a[66:67], v17 offset:5760
  v_mfma_f32_16x16x32_bf16 v[56:59], a[48:51], a[4:7], v[56:59]
  ds_read_b64_tr_b16 a[68:69], v18 offset:5120
  v_mfma_f32_16x16x32_bf16 v[60:63], a[52:55], a[4:7], v[60:63]
  ds_read_b64_tr_b16 a[70:71], v18 offset:5760
  v_mfma_f32_16x16x32_bf16 v[64:67], a[40:43], a[8:11], v[64:67]
  ds_read_b128 a[20:23], v10 offset:0
  v_mfma_f32_16x16x32_bf16 v[68:71], a[44:47], a[8:11], v[68:71]
  ds_read_b128 a[24:27], v10 offset:2048
  v_mfma_f32_16x16x32_bf16 v[72:75], a[48:51], a[8:11], v[72:75]
  ds_read_b128 a[28:31], v10 offset:4096
  v_mfma_f32_16x16x32_bf16 v[76:79], a[52:55], a[8:11], v[76:79]
  ds_read_b128 a[32:35], v10 offset:6144
  v_mfma_f32_16x16x32_bf16 v[80:83], a[40:43], a[12:15], v[80:83]
  ds_read_b128 a[36:39], v10 offset:8192
  s_add_u32 s37, s37, 40960
  v_mfma_f32_16x16x32_bf16 v[84:87], a[44:47], a[12:15], v[84:87]
  s_cmp_ge_u32 s37, 122880
  s_cselect_b32 s37, 0, s37
  v_mfma_f32_16x16x32_bf16 v[88:91], a[48:51], a[12:15], v[88:91]
  v_add_u32 v9, s37, v8
  v_add_u32 v15, s37, v11
  v_mfma_f32_16x16x32_bf16 v[92:95], a[52:55], a[12:15], v[92:95]
  v_add_u32 v16, s37, v12
  v_add_u32 v17, s37, v13
  v_mfma_f32_16x16x32_bf16 v[96:99], a[40:43], a[16:19], v[96:99]
  v_add_u32 v18, s37, v14
  v_xor_b32 v10, 64, v9
  v_mfma_f32_16x16x32_bf16 v[100:103], a[44:47], a[16:19], v[100:103]
  s_cmp_lg_u32 s38, 0
  v_mfma_f32_16x16x32_bf16 v[104:107], a[48:51], a[16:19], v[104:107]
  v_mfma_f32_16x16x32_bf16 v[108:111], a[52:55], a[16:19], v[108:111]
  s_cbranch_scc1 Lcloop_7
  s_waitcnt lgkmcnt(0)
  v_mfma_f32_16x16x32_bf16 v[32:35], a[56:59], a[20:23], v[32:35]
  v_mfma_f32_16x16x32_bf16 v[36:39], a[60:63], a[20:23], v[36:39]
  v_mfma_f32_16x16x32_bf16 v[40:43], a[64:67], a[20:23], v[40:43]
  v_mfma_f32_16x16x32_bf16 v[44:47], a[68:71], a[20:23], v[44:47]
  v_mfma_f32_16x16x32_bf16 v[48:51], a[56:59], a[24:27], v[48:51]
  v_mfma_f32_16x16x32_bf16 v[52:55], a[60:63], a[24:27], v[52:55]
  v_mfma_f32_16x16x32_bf16 v[56:59], a[64:67], a[24:27], v[56:59]
  v_mfma_f32_16x16x32_bf16 v[60:63], a[68:71], a[24:27], v[60:63]
  v_mfma_f32_16x16x32_bf16 v[64:67], a[56:59], a[28:31], v[64:67]
  v_mfma_f32_16x16x32_bf16 v[68:71], a[60:63], a[28:31], v[68:71]
  v_mfma_f32_16x16x32_bf16 v[72:75], a[64:67], a[28:31], v[72:75]
  v_mfma_f32_16x16x32_bf16 v[76:79], a[68:71], a[28:31], v[76:79]
  v_mfma_f32_16x16x32_bf16 v[80:83], a[56:59], a[32:35], v[80:83]
  v_mfma_f32_16x16x32_bf16 v[84:87], a[60:63], a[32:35], v[84:87]
  v_mfma_f32_16x16x32_bf16 v[88:91], a[64:67], a[32:35], v[88:91]
  v_mfma_f32_16x16x32_bf16 v[92:95], a[68:71], a[32:35], v[92:95]
  v_mfma_f32_16x16x32_bf16 v[96:99], a[56:59], a[36:39], v[96:99]
  v_mfma_f32_16x16x32_bf16 v[100:103], a[60:63], a[36:39], v[100:103]
  v_mfma_f32_16x16x32_bf16 v[104:107], a[64:67], a[36:39], v[104:107]
  v_mfma_f32_16x16x32_bf16 v[108:111], a[68:71], a[36:39], v[108:111]
  s_nop 7
L_epi1_start:
  ds_read_b64 v[8:9], v25 offset:0
  ds_read_b64 v[10:11], v25 offset:128
  ds_read_b64 v[12:13], v25 offset:256
  ds_read_b64 v[14:15], v25 offset:384
  ds_read_b64 v[16:17], v25 offset:512
  v_mov_b32_dpp v132, v96 row_newbcast:15 row_mask:0xf bank_mask:0xf
  v_mov_b32_dpp v133, v97 row_newbcast:15 row_mask:0xf bank_mask:0xf
  v_mov_b32_dpp v134, v98 row_newbcast:15 row_mask:0xf bank_mask:0xf
  v_mov_b32_dpp v135, v99 row_newbcast:15 row_mask:0xf bank_mask:0xf
  v_mov_b32_dpp v136, v100 row_newbcast:15 row_mask:0xf bank_mask:0xf
  v_mov_b32_dpp v137, v101 row_newbcast:15 row_mask:0xf bank_mask:0xf
  v_mov_b32_dpp v138, v102 row_newbcast:15 row_mask:0xf bank_mask:0xf
  v_mov_b32_dpp v139, v103 row_newbcast:15 row_mask:0xf bank_mask:0xf
  v_mov_b32_dpp v140, v104 row_newbcast:15 row_mask:0xf bank_mask:0xf
  v_mov_b32_dpp v141, v105 row_newbcast:15 row_mask:0xf bank_mask:0xf
  v_mov_b32_dpp v142, v106 row_newbcast:15 row_mask:0xf bank_mask:0xf
  v_mov_b32_dpp v143, v107 row_newbcast:15 row_mask:0xf bank_mask:0xf
  v_mov_b32_dpp v144, v108 row_newbcast:15 row_mask:0xf bank_mask:0xf
  v_mov_b32_dpp v145, v109 row_newbcast:15 row_mask:0xf bank_mask:0xf
  v_mov_b32_dpp v146, v110 row_newbcast:15 row_mask:0xf bank_mask:0xf
  v_mov_b32_dpp v147, v111 row_newbcast:15 row_mask:0xf bank_mask:0xf
  s_waitcnt lgkmcnt(0)
  v_pk_fma_f32 v[32:33], v[132:133], v[8:9], v[32:33] op_sel_hi:[1,0,1] neg_lo:[0,1,0] neg_hi:[0,1,0]
  v_pk_fma_f32 v[34:35], v[134:135], v[8:9], v[34:35] op_sel_hi:[1,0,1] neg_lo:[0,1,0] neg_hi:[0,1,0]
  v_pk_mul_f32 v[32:33], v[32:33], v[8:9] op_sel:[0,1] op_sel_hi:[1,1]
  v_pk_mul_f32 v[34:35], v[34:35], v[8:9] op_sel:[0,1] op_sel_hi:[1,1]
  v_cvt_pk_bf16_f32 v32, v32, v33
  v_cvt_pk_bf16_f32 v33, v34, v35
  ds_write_b64 v20, v[32:33] offset:0
  v_pk_fma_f32 v[36:37], v[136:137], v[8:9], v[36:37] op_sel_hi:[1,0,1] neg_lo:[0,1,0] neg_hi:[0,1,0]
  v_pk_fma_f32 v[38:39], v[138:139], v[8:9], v[38:39] op_sel_hi:[1,0,1] neg_lo:[0,1,0] neg_hi:[0,1,0]
  v_pk_mul_f32 v[36:37], v[36:37], v[8:9] op_sel:[0,1] op_sel_hi:[1,1]
  v_pk_mul_f32 v[38:39], v[38:39], v[8:9] op_sel:[0,1] op_sel_hi:[1,1]
  v_cvt_pk_bf16_f32 v36, v36, v37
  v_cvt_pk_bf16_f32 v37, v38, v39
  ds_write_b64 v21, v[36:37] offset:0
  v_pk_fma_f32 v[40:41], v[140:141], v[8:9], v[40:41] op_sel_hi:[1,0,1] neg_lo:[0,1,0] neg_hi:[0,1,0]
  v_pk_fma_f32 v[42:43], v[142:143], v[8:9], v[42:43] op_sel_hi:[1,0,1] neg_lo:[0,1,0] neg_hi:[0,1,0]
  v_pk_mul_f32 v[40:41], v[40:41], v[8:9] op_sel:[0,1] op_sel_hi:[1,1]
  v_pk_mul_f32 v[42:43], v[42:43], v[8:9] op_sel:[0,1] op_sel_hi:[1,1]
  v_cvt_pk_bf16_f32 v40, v40, v41
  v_cvt_pk_bf16_f32 v41, v42, v43
  ds_write_b64 v22, v[40:41] offset:0
  v_pk_fma_f32 v[44:45], v[144:145], v[8:9], v[44:45] op_sel_hi:[1,0,1] neg_lo:[0,1,0] neg_hi:[0,1,0]
  v_pk_fma_f32 v[46:47], v[146:147], v[8:9], v[46:47] op_sel_hi:[1,0,1] neg_lo:[0,1,0] neg_hi:[0,1,0]
  v_pk_mul_f32 v[44:45], v[44:45], v[8:9] op_sel:[0,1] op_sel_hi:[1,1]
  v_pk_mul_f32 v[46:47], v[46:47], v[8:9] op_sel:[0,1] op_sel_hi:[1,1]
  v_cvt_pk_bf16_f32 v44, v44, v45
  v_cvt_pk_bf16_f32 v45, v46, v47
  ds_write_b64 v23, v[44:45] offset:0
  v_pk_fma_f32 v[48:49], v[132:133], v[10:11], v[48:49] op_sel_hi:[1,0,1] neg_lo:[0,1,0] neg_hi:[0,1,0]
  v_pk_fma_f32 v[50:51], v[134:135], v[10:11], v[50:51] op_sel_hi:[1,0,1] neg_lo:[0,1,0] neg_hi:[0,1,0]
  v_pk_mul_f32 v[48:49], v[48:49], v[10:11] op_sel:[0,1] op_sel_hi:[1,1]
  v_pk_mul_f32 v[50:51], v[50:51], v[10:11] op_sel:[0,1] op_sel_hi:[1,1]
  v_cvt_pk_bf16_f32 v48, v48, v49
  v_cvt_pk_bf16_f32 v49, v50, v51
  ds_write_b64 v20, v[48:49] offset:7808
  v_pk_fma_f32 v[52:53], v[136:137], v[10:11], v[52:53] op_sel_hi:[1,0,1] neg_lo:[0,1,0] neg_hi:[0,1,0]
  v_pk_fma_f32 v[54:55], v[138:139], v[10:11], v[54:55] op_sel_hi:[1,0,1] neg_lo:[0,1,0] neg_hi:[0,1,0]
  v_pk_mul_f32 v[52:53], v[52:53], v[10:11] op_sel:[0,1] op_sel_hi:[1,1]
  v_pk_mul_f32 v[54:55], v[54:55], v[10:11] op_sel:[0,1] op_sel_hi:[1,1]
  v_cvt_pk_bf16_f32 v52, v52, v53
  v_cvt_pk_bf16_f32 v53, v54, v55
  ds_write_b64 v21, v[52:53] offset:7808
  v_pk_fma_f32 v[56:57], v[140:141], v[10:11], v[56:57] op_sel_hi:[1,0,1] neg_lo:[0,1,0] neg_hi:[0,1,0]
  v_pk_fma_f32 v[58:59], v[142:143], v[10:11], v[58:59] op_sel_hi:[1,0,1] neg_lo:[0,1,0] neg_hi:[0,1,0]
  v_pk_mul_f32 v[56:57], v[56:57], v[10:11] op_sel:[0,1] op_sel_hi:[1,1]
  v_pk_mul_f32 v[58:59], v[58:59], v[10:11] op_sel:[0,1] op_sel_hi:[1,1]
  v_cvt_pk_bf16_f32 v56, v56, v57
  v_cvt_pk_bf16_f32 v57, v58, v59
  ds_write_b64 v22, v[56:57] offset:7808
  v_pk_fma_f32 v[60:61], v[144:145], v[10:11], v[60:61] op_sel_hi:[1,0,1] neg_lo:[0,1,0] neg_hi:[0,1,0]
  v_pk_fma_f32 v[62:63], v[146:147], v[10:11], v[62:63] op_sel_hi:[1,0,1] neg_lo:[0,1,0] neg_hi:[0,1,0]
  v_pk_mul_f32 v[60:61], v[60:61], v[10:11] op_sel:[0,1] op_sel_hi:[1,1]
  v_pk_mul_f32 v[62:63], v[62:63], v[10:11] op_sel:[0,1] op_sel_hi:[1,1]
  v_cvt_pk_bf16_f32 v60, v60, v61
  v_cvt_pk_bf16_f32 v61, v62, v63
  ds_write_b64 v23, v[60:61] offset:7808
  v_pk_fma_f32 v[64:65], v[132:133], v[12:13], v[64:65] op_sel_hi:[1,0,1] neg_lo:[0,1,0] neg_hi:[0,1,0]
  v_pk_fma_f32 v[66:67], v[134:135], v[12:13], v[66:67] op_sel_hi:[1,0,1] neg_lo:[0,1,0] neg_hi:[0,1,0]
  v_pk_mul_f32 v[64:65], v[64:65], v[12:13] op_sel:[0,1] op_sel_hi:[1,1]
  v_pk_mul_f32 v[66:67], v[66:67], v[12:13] op_sel:[0,1] op_sel_hi:[1,1]
  v_cvt_pk_bf16_f32 v64, v64, v65
  v_cvt_pk_bf16_f32 v65, v66, v67
  ds_write_b64 v20, v[64:65] offset:15616
  v_pk_fma_f32 v[68:69], v[136:137], v[12:13], v[68:69] op_sel_hi:[1,0,1] neg_lo:[0,1,0] neg_hi:[0,1,0]
  v_pk_fma_f32 v[70:71], v[138:139], v[12:13], v[70:71] op_sel_hi:[1,0,1] neg_lo:[0,1,0] neg_hi:[0,1,0]
  v_pk_mul_f32 v[68:69], v[68:69], v[12:13] op_sel:[0,1] op_sel_hi:[1,1]
  v_pk_mul_f32 v[70:71], v[70:71], v[12:13] op_sel:[0,1] op_sel_hi:[1,1]
  v_cvt_pk_bf16_f32 v68, v68, v69
  v_cvt_pk_bf16_f32 v69, v70, v71
  ds_write_b64 v21, v[68:69] offset:15616
  v_pk_fma_f32 v[72:73], v[140:141], v[12:13], v[72:73] op_sel_hi:[1,0,1] neg_lo:[0,1,0] neg_hi:[0,1,0]
  v_pk_fma_f32 v[74:75], v[142:143], v[12:13], v[74:75] op_sel_hi:[1,0,1] neg_lo:[0,1,0] neg_hi:[0,1,0]
  v_pk_mul_f32 v[72:73], v[72:73], v[12:13] op_sel:[0,1] op_sel_hi:[1,1]
  v_pk_mul_f32 v[74:75], v[74:75], v[12:13] op_sel:[0,1] op_sel_hi:[1,1]
  v_cvt_pk_bf16_f32 v72, v72, v73
  v_cvt_pk_bf16_f32 v73, v74, v75
  ds_write_b64 v22, v[72:73] offset:15616
  v_pk_fma_f32 v[76:77], v[144:145], v[12:13], v[76:77] op_sel_hi:[1,0,1] neg_lo:[0,1,0] neg_hi:[0,1,0]
  v_pk_fma_f32 v[78:79], v[146:147], v[12:13], v[78:79] op_sel_hi:[1,0,1] neg_lo:[0,1,0] neg_hi:[0,1,0]
  v_pk_mul_f32 v[76:77], v[76:77], v[12:13] op_sel:[0,1] op_sel_hi:[1,1]
  v_pk_mul_f32 v[78:79], v[78:79], v[12:13] op_sel:[0,1] op_sel_hi:[1,1]
  v_cvt_pk_bf16_f32 v76, v76, v77
  v_cvt_pk_bf16_f32 v77, v78, v79
  ds_write_b64 v23, v[76:77] offset:15616
  v_pk_fma_f32 v[80:81], v[132:133], v[14:15], v[80:81] op_sel_hi:[1,0,1] neg_lo:[0,1,0] neg_hi:[0,1,0]
  v_pk_fma_f32 v[82:83], v[134:135], v[14:15], v[82:83] op_sel_hi:[1,0,1] neg_lo:[0,1,0] neg_hi:[0,1,0]
  v_pk_mul_f32 v[80:81], v[80:81], v[14:15] op_sel:[0,1] op_sel_hi:[1,1]
  v_pk_mul_f32 v[82:83], v[82:83], v[14:15] op_sel:[0,1] op_sel_hi:[1,1]
  v_cvt_pk_bf16_f32 v80, v80, v81
  v_cvt_pk_bf16_f32 v81, v82, v83
  ds_write_b64 v20, v[80:81] offset:23424
  v_pk_fma_f32 v[84:85], v[136:137], v[14:15], v[84:85] op_sel_hi:[1,0,1] neg_lo:[0,1,0] neg_hi:[0,1,0]
  v_pk_fma_f32 v[86:87], v[138:139], v[14:15], v[86:87] op_sel_hi:[1,0,1] neg_lo:[0,1,0] neg_hi:[0,1,0]
  v_pk_mul_f32 v[84:85], v[84:85], v[14:15] op_sel:[0,1] op_sel_hi:[1,1]
  v_pk_mul_f32 v[86:87], v[86:87], v[14:15] op_sel:[0,1] op_sel_hi:[1,1]
  v_cvt_pk_bf16_f32 v84, v84, v85
  v_cvt_pk_bf16_f32 v85, v86, v87
  ds_write_b64 v21, v[84:85] offset:23424
  v_pk_fma_f32 v[88:89], v[140:141], v[14:15], v[88:89] op_sel_hi:[1,0,1] neg_lo:[0,1,0] neg_hi:[0,1,0]
  v_pk_fma_f32 v[90:91], v[142:143], v[14:15], v[90:91] op_sel_hi:[1,0,1] neg_lo:[0,1,0] neg_hi:[0,1,0]
  v_pk_mul_f32 v[88:89], v[88:89], v[14:15] op_sel:[0,1] op_sel_hi:[1,1]
  v_pk_mul_f32 v[90:91], v[90:91], v[14:15] op_sel:[0,1] op_sel_hi:[1,1]
  v_cvt_pk_bf16_f32 v88, v88, v89
  v_cvt_pk_bf16_f32 v89, v90, v91
  ds_write_b64 v22, v[88:89] offset:23424
  v_pk_fma_f32 v[92:93], v[144:145], v[14:15], v[92:93] op_sel_hi:[1,0,1] neg_lo:[0,1,0] neg_hi:[0,1,0]
  v_pk_fma_f32 v[94:95], v[146:147], v[14:15], v[94:95] op_sel_hi:[1,0,1] neg_lo:[0,1,0] neg_hi:[0,1,0]
  v_pk_mul_f32 v[92:93], v[92:93], v[14:15] op_sel:[0,1] op_sel_hi:[1,1]
  v_pk_mul_f32 v[94:95], v[94:95], v[14:15] op_sel:[0,1] op_sel_hi:[1,1]
  v_cvt_pk_bf16_f32 v92, v92, v93
  v_cvt_pk_bf16_f32 v93, v94, v95
  ds_write_b64 v23, v[92:93] offset:23424
  v_pk_fma_f32 v[96:97], v[132:133], v[16:17], v[96:97] op_sel_hi:[1,0,1] neg_lo:[0,1,0] neg_hi:[0,1,0]
  v_pk_fma_f32 v[98:99], v[134:135], v[16:17], v[98:99] op_sel_hi:[1,0,1] neg_lo:[0,1,0] neg_hi:[0,1,0]
  v_pk_mul_f32 v[96:97], v[96:97], v[16:17] op_sel:[0,1] op_sel_hi:[1,1]
  v_pk_mul_f32 v[98:99], v[98:99], v[16:17] op_sel:[0,1] op_sel_hi:[1,1]
  v_cvt_pk_bf16_f32 v96, v96, v97
  v_cvt_pk_bf16_f32 v97, v98, v99
  ds_write_b64 v20, v[96:97] offset:31232
  v_pk_fma_f32 v[100:101], v[136:137], v[16:17], v[100:101] op_sel_hi:[1,0,1] neg_lo:[0,1,0] neg_hi:[0,1,0]
  v_pk_fma_f32 v[102:103], v[138:139], v[16:17], v[102:103] op_sel_hi:[1,0,1] neg_lo:[0,1,0] neg_hi:[0,1,0]
  v_pk_mul_f32 v[100:101], v[100:101], v[16:17] op_sel:[0,1] op_sel_hi:[1,1]
  v_pk_mul_f32 v[102:103], v[102:103], v[16:17] op_sel:[0,1] op_sel_hi:[1,1]
  v_cvt_pk_bf16_f32 v100, v100, v101
  v_cvt_pk_bf16_f32 v101, v102, v103
  ds_write_b64 v21, v[100:101] offset:31232
  v_pk_fma_f32 v[104:105], v[140:141], v[16:17], v[104:105] op_sel_hi:[1,0,1] neg_lo:[0,1,0] neg_hi:[0,1,0]
  v_pk_fma_f32 v[106:107], v[142:143], v[16:17], v[106:107] op_sel_hi:[1,0,1] neg_lo:[0,1,0] neg_hi:[0,1,0]
  v_pk_mul_f32 v[104:105], v[104:105], v[16:17] op_sel:[0,1] op_sel_hi:[1,1]
  v_pk_mul_f32 v[106:107], v[106:107], v[16:17] op_sel:[0,1] op_sel_hi:[1,1]
  v_cvt_pk_bf16_f32 v104, v104, v105
  v_cvt_pk_bf16_f32 v105, v106, v107
  ds_write_b64 v22, v[104:105] offset:31232
  v_pk_fma_f32 v[108:109], v[144:145], v[16:17], v[108:109] op_sel_hi:[1,0,1] neg_lo:[0,1,0] neg_hi:[0,1,0]
  v_pk_fma_f32 v[110:111], v[146:147], v[16:17], v[110:111] op_sel_hi:[1,0,1] neg_lo:[0,1,0] neg_hi:[0,1,0]
  v_pk_mul_f32 v[108:109], v[108:109], v[16:17] op_sel:[0,1] op_sel_hi:[1,1]
  v_pk_mul_f32 v[110:111], v[110:111], v[16:17] op_sel:[0,1] op_sel_hi:[1,1]
  v_cvt_pk_bf16_f32 v108, v108, v109
  v_cvt_pk_bf16_f32 v109, v110, v111
  ds_write_b64 v23, v[108:109] offset:31232
  s_waitcnt lgkmcnt(0)
  s_barrier
  s_barrier
  ds_read_b128 v[32:35], v26
  s_cmp_ge_u32 s36, 2
  s_cbranch_scc1 Lost_8
  ds_read_b128 v[36:39], v27
  s_waitcnt lgkmcnt(0)
  buffer_store_dwordx4 v[36:39], v29, s[20:23], 0 offen sc1
Lost_8:
  s_waitcnt lgkmcnt(0)
  buffer_store_dwordx4 v[32:35], v28, s[20:23], 0 offen sc1
  s_lshl_b32 s85, s32, 3
  s_add_u32 s85, s85, s33
  s_lshl_b32 s85, s85, 7
  s_add_u32 s85, s85, 0x8000
  s_waitcnt vmcnt(0)
  s_barrier
  s_cmp_eq_u32 s36, 0
  s_cbranch_scc0 Lpub_9
  s_cmp_eq_u32 s85, -1
  s_cbranch_scc1 Lpub_9
  v_mov_b32 v140, s78
  v_mov_b32 v141, s79
  v_mov_b32 v142, s85
  s_mov_b64 exec, 1
  buffer_store_dwordx2 v[140:141], v142, s[88:91], 0 offen sc1
  s_mov_b64 exec, -1
Lpub_9:
  s_branch Lnext_1
Linv_2:
  s_waitcnt lgkmcnt(0)
  s_add_u32 s88, s62, 0x1900000
  s_addc_u32 s89, s63, 0
  s_and_b32 s89, s89, 0xffff
  s_mov_b32 s90, 0x20000
  s_mov_b32 s91, 0x20000
  s_cmp_eq_u32 s36, 0
  s_cbranch_scc0 Lnonce_10
  s_mov_b32 s80, s60
  s_and_b32 s81, s61, 0xffff
  s_mov_b32 s82, 0x100
  s_mov_b32 s83, 0x20000
  v_mov_b32 v158, 0
  s_mov_b32 s38, 0x40000
Lnloop_11:
  buffer_load_dwordx2 v[156:157], v158, s[80:83], 0 offen sc1
  s_waitcnt vmcnt(0)
Lnchk_13:
  v_readfirstlane_b32 s78, v156
  v_readfirstlane_b32 s79, v157
  s_nop 3
  s_cmp_lg_u32 s78, 0
  s_cbranch_scc1 Lndone_12
  s_sub_u32 s38, s38, 1
  s_cmp_lg_u32 s38, 0
  s_cbranch_scc1 Lnloop_11
Lndone_12:
  v_mov_b32 v158, 163832
  s_mov_b64 exec, 1
  ds_write_b64 v158, v[156:157]
  s_mov_b64 exec, -1
  s_waitcnt lgkmcnt(0)
Lnonce_10:
Lnext_1:
  s_and_b32 s39, s2, 7
  s_lshr_b32 s40, s2, 3
  s_lshl_b32 s39, s39, 5
  s_add_u32 s39, s39, s40
  s_cmp_lt_u32 s39, 250
  s_cselect_b32 s87, 1, 0
  s_mul_i32 s32, s39, 6554
  s_lshr_b32 s32, s32, 16
  s_mul_i32 s33, s32, 10
  s_sub_u32 s33, s39, s33
  s_cmp_eq_u32 s87, 0
  s_cbranch_scc1 Linv_15
  s_mul_i32 s34, s32, 82
  s_mul_i32 s35, s33, 64
  s_add_u32 s68, s34, 82
  s_min_u32 s68, s68, 2048
  v_and_b32 v3, 15, v2
  v_lshrrev_b32 v4, 4, v2
  s_lshr_b32 s66, s36, 1
  s_and_b32 s67, s36, 1
  s_mul_i32 s40, s66, 48
  v_lshrrev_b32 v5, 1, v3
  v_xor_b32 v5, v4, v5
  v_lshlrev_b32 v5, 4, v5
  v_lshl_add_u32 v8, v3, 7, v5
  s_lshl_b32 s39, s40, 7
  v_add_u32 v8, s39, v8
  v_lshrrev_b32 v5, 2, v3
  v_lshl_add_u32 v6, v4, 3, v5
  v_lshlrev_b32 v6, 7, v6
  v_lshrrev_b32 v5, 1, v5
  v_and_b32 v7, 1, v4
  v_lshl_or_b32 v5, v7, 1, v5
  v_lshl_add_u32 v6, v5, 5, v6
  v_and_b32 v5, 3, v3
  v_lshl_add_u32 v9, v5, 3, v6
  s_lshl_b32 s39, s67, 6
  v_xor_b32 v9, s39, v9
  v_lshrrev_b32 v5, 1, v4
  v_and_b32 v6, 7, v3
  v_xor_b32 v5, v5, v6
  v_lshlrev_b32 v5, 4, v5
  v_and_b32 v6, 1, v4
  v_lshl_add_u32 v5, v6, 3, v5
  v_lshl_add_u32 v17, v3, 7, v5
  v_add_u32 v17, 0, v17
  s_mul_i32 s39, s66, 6144
  v_add_u32 v17, s39, v17
  s_lshl_b32 s39, s67, 6
  v_xor_b32 v17, s39, v17
  v_xor_b32 v18, 32, v17
  v_mov_b32 v32, 0
  v_mov_b32 v33, 0
  v_mov_b32 v34, 0
  v_mov_b32 v35, 0
  v_mov_b32 v36, 0
  v_mov_b32 v37, 0
  v_mov_b32 v38, 0
  v_mov_b32 v39, 0
  v_mov_b32 v40, 0
  v_mov_b32 v41, 0
  v_mov_b32 v42, 0
  v_mov_b32 v43, 0
  v_mov_b32 v44, 0
  v_mov_b32 v45, 0
  v_mov_b32 v46, 0
  v_mov_b32 v47, 0
  v_mov_b32 v48, 0
  v_mov_b32 v49, 0
  v_mov_b32 v50, 0
  v_mov_b32 v51, 0
  v_mov_b32 v52, 0
  v_mov_b32 v53, 0
  v_mov_b32 v54, 0
  v_mov_b32 v55, 0
  s_mov_b32 s37, 0
  s_mov_b32 s93, 73728
  v_add_u32 v10, s37, v8
  v_add_u32 v12, s93, v9
  v_xor_b32 v11, 64, v10
  v_xor_b32 v13, 32, v12
  s_add_u32 s20, s62, 0xb00000
  s_addc_u32 s21, s63, 0
  s_and_b32 s21, s21, 0xffff
  s_mov_b32 s22, 0x280000
  s_mov_b32 s23, 0x20000
  s_mov_b32 s24, s44
  s_mov_b32 s25, s45
  s_and_b32 s25, s25, 0xffff
  s_mov_b32 s26, 0x280000
  s_mov_b32 s27, 0x20000
  s_add_u32 s28, s62, 0x1800000
  s_addc_u32 s29, s63, 0
  s_and_b32 s29, s29, 0xffff
  s_mov_b32 s30, 0x5dc00
  s_mov_b32 s31, 0x20000
  s_mul_i32 s69, s33, 2
  s_mul_i32 s39, s32, 13
  s_add_u32 s69, s69, s39
  s_lshr_b32 s69, s69, 2
  s_mul_i32 s39, s69, 8192
  s_lshr_b32 s39, s39, 16
  s_mul_i32 s39, s39, 8
  s_sub_u32 s69, s69, s39
  s_add_u32 s92, s69, 1
  s_cmp_ge_u32 s92, 8
  s_cselect_b32 s92, 0, s92
  s_lshl_b32 s41, 1, s69
  s_sub_u32 s95, s69, 8
  s_lshl_b32 s95, s95, 2
  s_lshl_b32 s95, 15, s95
  s_cmp_ge_u32 s69, 8
  s_cselect_b32 s41, s95, s41
  s_lshl_b32 s94, 1, s92
  s_sub_u32 s95, s92, 8
  s_lshl_b32 s95, s95, 2
  s_lshl_b32 s95, 15, s95
  s_cmp_ge_u32 s92, 8
  s_cselect_b32 s94, s95, s94
  s_or_b32 s41, s41, s94
  s_lshr_b32 s39, s34, 6
  s_sub_u32 s40, s68, 1
  s_lshr_b32 s40, s40, 6
  s_cmp_eq_u32 s36, 0
  s_cbranch_scc0 Lpollskip_16
  v_and_b32 v141, 7, v2
  v_mov_b32 v142, s41
  v_lshrrev_b32 v142, v141, v142
  v_and_b32 v142, 1, v142
  v_lshrrev_b32 v140, 3, v2
  v_add_u32 v140, s39, v140
  v_cmp_ge_u32 vcc, s40, v140
  v_cmp_eq_u32 s[82:83], 1, v142
  v_lshl_add_u32 v140, v140, 3, v141
  v_lshlrev_b32 v140, 7, v140
  v_add_u32 v140, 0x8000, v140
  s_and_b64 vcc, vcc, s[82:83]
  s_and_saveexec_b64 s[80:81], vcc
  s_mov_b32 s38, 0x40000
Lpoll_17:
  buffer_load_dwordx2 v[142:143], v140, s[88:91], 0 offen sc1
  s_waitcnt vmcnt(0)
  v_cmp_ne_u64 vcc, s[78:79], v[142:143]
  s_cbranch_vccz Lpolldone_18
  s_sub_u32 s38, s38, 1
  s_cmp_lg_u32 s38, 0
  s_cbranch_scc1 Lpoll_17
Lpolldone_18:
  s_mov_b64 exec, s[80:81]
Lpollskip_16:
  s_barrier
  v_lshrrev_b32 v112, 3, v2
  v_and_b32 v113, 7, v2
  v_xor_b32 v108, v113, v112
  v_lshlrev_b32 v108, 4, v108
  v_lshl_add_u32 v108, v112, 7, v108
  s_lshl_b32 s39, s36, 10
  s_add_u32 s39, s39, 0
  v_add_u32 v108, s39, v108
  s_lshl_b32 s39, s36, 3
  s_add_u32 s39, s39, s34
  v_add_u32 v111, s39, v112
  v_mul_u32_u24 v109, 1280, v111
  s_lshl_b32 s39, s35, 1
  v_lshl_add_u32 v109, v113, 4, v109
  v_add_u32 v109, s39, v109
  v_add_u32 v110, 81920, v109
  v_mov_b32 v114, 0x80000000
  v_cmp_gt_u32 vcc, s68, v111
  v_add_u32 v115, 64, v111
  s_nop 0
  v_cndmask_b32 v109, v114, v109, vcc
  v_cmp_gt_u32 vcc, s68, v115
  s_nop 1
  v_cndmask_b32 v110, v114, v110, vcc
  buffer_load_dwordx4 v[100:103], v109, s[24:27], 0 offen
  buffer_load_dwordx4 v[104:107], v110, s[24:27], 0 offen
  s_lshr_b32 s39, s34, 6
  s_sub_u32 s40, s68, 1
  s_lshr_b32 s40, s40, 6
  s_mul_i32 s39, s39, 8
  s_add_u32 s40, s40, 1
  s_mul_i32 s40, s40, 8
  s_cmp_eq_u32 s36, 0
  s_cbranch_scc0 Lpollskip_19
  v_add_u32 v140, s39, v2
  v_cmp_gt_u32 vcc, s40, v140
  v_lshlrev_b32 v140, 7, v140
  v_add_u32 v140, 32768, v140
  s_and_saveexec_b64 s[80:81], vcc
  s_mov_b32 s38, 0x40000
Lpoll_20:
  buffer_load_dwordx2 v[142:143], v140, s[88:91], 0 offen sc1
  s_waitcnt vmcnt(0)
  v_cmp_ne_u64 vcc, s[78:79], v[142:143]
  s_cbranch_vccz Lpolldone_21
  s_sub_u32 s38, s38, 1
  s_cmp_lg_u32 s38, 0
  s_cbranch_scc1 Lpoll_20
Lpolldone_21:
  s_mov_b64 exec, s[80:81]
Lpollskip_19:
  s_barrier
  ds_read_b64_tr_b16 a[0:1], v12 offset:0
  ds_read_b64_tr_b16 a[2:3], v12 offset:512
  ds_read_b64_tr_b16 a[4:5], v13 offset:0
  ds_read_b64_tr_b16 a[6:7], v13 offset:512
  ds_read_b128 a[16:19], v10 offset:0
  ds_read_b128 a[20:23], v10 offset:2048
  ds_read_b128 a[24:27], v10 offset:4096
  ds_read_b64_tr_b16 a[8:9], v12 offset:4096
  ds_read_b64_tr_b16 a[10:11], v12 offset:4608
  ds_read_b64_tr_b16 a[12:13], v13 offset:4096
  ds_read_b64_tr_b16 a[14:15], v13 offset:4608
  ds_read_b128 a[28:31], v11 offset:0
  ds_read_b128 a[32:35], v11 offset:2048
  ds_read_b128 a[36:39], v11 offset:4096
  s_add_u32 s37, s37, 12288
  s_cmp_ge_u32 s37, 73728
  s_cselect_b32 s37, 0, s37
  s_add_u32 s93, s93, 8192
  s_cmp_ge_u32 s93, 155648
  s_cselect_b32 s93, 73728, s93
  v_add_u32 v10, s37, v8
  v_add_u32 v12, s93, v9
  v_xor_b32 v11, 64, v10
  v_xor_b32 v13, 32, v12
  s_mov_b32 s38, 4
.p2align 6
Lcloop_22:
  s_waitcnt lgkmcnt(0)
  s_barrier
  v_mfma_f32_16x16x32_bf16 v[32:35], a[0:3], a[16:19], v[32:35]
  ds_read_b64_tr_b16 a[40:41], v12 offset:0
  ds_read_b64_tr_b16 a[42:43], v12 offset:512
  v_mfma_f32_16x16x32_bf16 v[36:39], a[4:7], a[16:19], v[36:39]
  ds_read_b64_tr_b16 a[44:45], v13 offset:0
  ds_read_b64_tr_b16 a[46:47], v13 offset:512
  v_mfma_f32_16x16x32_bf16 v[40:43], a[0:3], a[20:23], v[40:43]
  ds_read_b128 a[56:59], v10 offset:0
  ds_read_b128 a[60:63], v10 offset:2048
  v_mfma_f32_16x16x32_bf16 v[44:47], a[4:7], a[20:23], v[44:47]
  ds_read_b128 a[64:67], v10 offset:4096
  ds_read_b64_tr_b16 a[48:49], v12 offset:4096
  v_mfma_f32_16x16x32_bf16 v[48:51], a[0:3], a[24:27], v[48:51]
  ds_read_b64_tr_b16 a[50:51], v12 offset:4608
  ds_read_b64_tr_b16 a[52:53], v13 offset:4096
  v_mfma_f32_16x16x32_bf16 v[52:55], a[4:7], a[24:27], v[52:55]
  ds_read_b64_tr_b16 a[54:55], v13 offset:4608
  ds_read_b128 a[68:71], v11 offset:0
  v_mfma_f32_16x16x32_bf16 v[32:35], a[8:11], a[28:31], v[32:35]
  ds_read_b128 a[72:75], v11 offset:2048
  ds_read_b128 a[76:79], v11 offset:4096
  v_mfma_f32_16x16x32_bf16 v[36:39], a[12:15], a[28:31], v[36:39]
  s_add_u32 s37, s37, 12288
  s_cmp_ge_u32 s37, 73728
  v_mfma_f32_16x16x32_bf16 v[40:43], a[8:11], a[32:35], v[40:43]
  s_cselect_b32 s37, 0, s37
  s_add_u32 s93, s93, 8192
  v_mfma_f32_16x16x32_bf16 v[44:47], a[12:15], a[32:35], v[44:47]
  s_cmp_ge_u32 s93, 155648
  s_cselect_b32 s93, 73728, s93
  v_mfma_f32_16x16x32_bf16 v[48:51], a[8:11], a[36:39], v[48:51]
  v_add_u32 v10, s37, v8
  v_add_u32 v12, s93, v9
  v_mfma_f32_16x16x32_bf16 v[52:55], a[12:15], a[36:39], v[52:55]
  v_xor_b32 v11, 64, v10
  v_xor_b32 v13, 32, v12
  s_sub_u32 s38, s38, 1
  s_waitcnt lgkmcnt(0)
  s_barrier
  v_mfma_f32_16x16x32_bf16 v[32:35], a[40:43], a[56:59], v[32:35]
  ds_read_b64_tr_b16 a[0:1], v12 offset:0
  ds_read_b64_tr_b16 a[2:3], v12 offset:512
  v_mfma_f32_16x16x32_bf16 v[36:39], a[44:47], a[56:59], v[36:39]
  ds_read_b64_tr_b16 a[4:5], v13 offset:0
  ds_read_b64_tr_b16 a[6:7], v13 offset:512
  v_mfma_f32_16x16x32_bf16 v[40:43], a[40:43], a[60:63], v[40:43]
  ds_read_b128 a[16:19], v10 offset:0
  ds_read_b128 a[20:23], v10 offset:2048
  v_mfma_f32_16x16x32_bf16 v[44:47], a[44:47], a[60:63], v[44:47]
  ds_read_b128 a[24:27], v10 offset:4096
  ds_read_b64_tr_b16 a[8:9], v12 offset:4096
  v_mfma_f32_16x16x32_bf16 v[48:51], a[40:43], a[64:67], v[48:51]
  ds_read_b64_tr_b16 a[10:11], v12 offset:4608
  ds_read_b64_tr_b16 a[12:13], v13 offset:4096
  v_mfma_f32_16x16x32_bf16 v[52:55], a[44:47], a[64:67], v[52:55]
  ds_read_b64_tr_b16 a[14:15], v13 offset:4608
  ds_read_b128 a[28:31], v11 offset:0
  v_mfma_f32_16x16x32_bf16 v[32:35], a[48:51], a[68:71], v[32:35]
  ds_read_b128 a[32:35], v11 offset:2048
  ds_read_b128 a[36:39], v11 offset:4096
  v_mfma_f32_16x16x32_bf16 v[36:39], a[52:55], a[68:71], v[36:39]
  s_add_u32 s37, s37, 12288
  s_cmp_ge_u32 s37, 73728
  v_mfma_f32_16x16x32_bf16 v[40:43], a[48:51], a[72:75], v[40:43]
  s_cselect_b32 s37, 0, s37
  s_add_u32 s93, s93, 8192
  v_mfma_f32_16x16x32_bf16 v[44:47], a[52:55], a[72:75], v[44:47]
  s_cmp_ge_u32 s93, 155648
  s_cselect_b32 s93, 73728, s93
  v_mfma_f32_16x16x32_bf16 v[48:51], a[48:51], a[76:79], v[48:51]
  v_add_u32 v10, s37, v8
  v_add_u32 v12, s93, v9
  v_mfma_f32_16x16x32_bf16 v[52:55], a[52:55], a[76:79], v[52:55]
  v_xor_b32 v11, 64, v10
  v_xor_b32 v13, 32, v12
  s_cmp_lg_u32 s38, 0
  s_cbranch_scc1 Lcloop_22
  s_waitcnt lgkmcnt(0)
  s_barrier
  v_mfma_f32_16x16x32_bf16 v[32:35], a[0:3], a[16:19], v[32:35]
  ds_read_b64_tr_b16 a[40:41], v12 offset:0
  ds_read_b64_tr_b16 a[42:43], v12 offset:512
  v_mfma_f32_16x16x32_bf16 v[36:39], a[4:7], a[16:19], v[36:39]
  ds_read_b64_tr_b16 a[44:45], v13 offset:0
  ds_read_b64_tr_b16 a[46:47], v13 offset:512
  v_mfma_f32_16x16x32_bf16 v[40:43], a[0:3], a[20:23], v[40:43]
  ds_read_b128 a[56:59], v10 offset:0
  ds_read_b128 a[60:63], v10 offset:2048
  v_mfma_f32_16x16x32_bf16 v[44:47], a[4:7], a[20:23], v[44:47]
  ds_read_b128 a[64:67], v10 offset:4096
  ds_read_b64_tr_b16 a[48:49], v12 offset:4096
  v_mfma_f32_16x16x32_bf16 v[48:51], a[0:3], a[24:27], v[48:51]
  ds_read_b64_tr_b16 a[50:51], v12 offset:4608
  ds_read_b64_tr_b16 a[52:53], v13 offset:4096
  v_mfma_f32_16x16x32_bf16 v[52:55], a[4:7], a[24:27], v[52:55]
  ds_read_b64_tr_b16 a[54:55], v13 offset:4608
  ds_read_b128 a[68:71], v11 offset:0
  v_mfma_f32_16x16x32_bf16 v[32:35], a[8:11], a[28:31], v[32:35]
  ds_read_b128 a[72:75], v11 offset:2048
  ds_read_b128 a[76:79], v11 offset:4096
  v_mfma_f32_16x16x32_bf16 v[36:39], a[12:15], a[28:31], v[36:39]
  s_add_u32 s37, s37, 12288
  s_cmp_ge_u32 s37, 73728
  v_mfma_f32_16x16x32_bf16 v[40:43], a[8:11], a[32:35], v[40:43]
  s_cselect_b32 s37, 0, s37
  s_add_u32 s93, s93, 8192
  v_mfma_f32_16x16x32_bf16 v[44:47], a[12:15], a[32:35], v[44:47]
  s_cmp_ge_u32 s93, 155648
  s_cselect_b32 s93, 73728, s93
  v_mfma_f32_16x16x32_bf16 v[48:51], a[8:11], a[36:39], v[48:51]
  v_add_u32 v10, s37, v8
  v_add_u32 v12, s93, v9
  v_mfma_f32_16x16x32_bf16 v[52:55], a[12:15], a[36:39], v[52:55]
  v_xor_b32 v11, 64, v10
  v_xor_b32 v13, 32, v12
  s_waitcnt lgkmcnt(0)
  v_mfma_f32_16x16x32_bf16 v[32:35], a[40:43], a[56:59], v[32:35]
  v_mfma_f32_16x16x32_bf16 v[36:39], a[44:47], a[56:59], v[36:39]
  v_mfma_f32_16x16x32_bf16 v[40:43], a[40:43], a[60:63], v[40:43]
  v_mfma_f32_16x16x32_bf16 v[44:47], a[44:47], a[60:63], v[44:47]
  v_mfma_f32_16x16x32_bf16 v[48:51], a[40:43], a[64:67], v[48:51]
  v_mfma_f32_16x16x32_bf16 v[52:55], a[44:47], a[64:67], v[52:55]
  v_mfma_f32_16x16x32_bf16 v[32:35], a[48:51], a[68:71], v[32:35]
  v_mfma_f32_16x16x32_bf16 v[36:39], a[52:55], a[68:71], v[36:39]
  v_mfma_f32_16x16x32_bf16 v[40:43], a[48:51], a[72:75], v[40:43]
  v_mfma_f32_16x16x32_bf16 v[44:47], a[52:55], a[72:75], v[44:47]
  v_mfma_f32_16x16x32_bf16 v[48:51], a[48:51], a[76:79], v[48:51]
  v_mfma_f32_16x16x32_bf16 v[52:55], a[52:55], a[76:79], v[52:55]
  s_nop 7
  v_cvt_pk_bf16_f32 v32, v32, v33
  v_cvt_pk_bf16_f32 v33, v34, v35
  ds_write_b64 v17, v[32:33] offset:0
  v_cvt_pk_bf16_f32 v36, v36, v37
  v_cvt_pk_bf16_f32 v37, v38, v39
  ds_write_b64 v18, v[36:37] offset:0
  v_cvt_pk_bf16_f32 v40, v40, v41
  v_cvt_pk_bf16_f32 v41, v42, v43
  ds_write_b64 v17, v[40:41] offset:2048
  v_cvt_pk_bf16_f32 v44, v44, v45
  v_cvt_pk_bf16_f32 v45, v46, v47
  ds_write_b64 v18, v[44:45] offset:2048
  v_cvt_pk_bf16_f32 v48, v48, v49
  v_cvt_pk_bf16_f32 v49, v50, v51
  ds_write_b64 v17, v[48:49] offset:4096
  v_cvt_pk_bf16_f32 v52, v52, v53
  v_cvt_pk_bf16_f32 v53, v54, v55
  ds_write_b64 v18, v[52:53] offset:4096
  s_waitcnt lgkmcnt(0)
  s_barrier
  ds_read_b128 v[16:19], v108 offset:0
  ds_read_b128 v[20:23], v108 offset:8192
  v_mov_b32 v26, 0x3f803f80
  s_waitcnt vmcnt(0) lgkmcnt(0)
  v_lshlrev_b32 v28, 16, v16
  v_and_b32 v29, 0xffff0000, v16
  v_lshlrev_b32 v30, 16, v100
  v_and_b32 v31, 0xffff0000, v100
  v_pk_add_f32 v[28:29], v[28:29], v[30:31]
  v_cvt_pk_bf16_f32 v16, v28, v29
  v_lshlrev_b32 v28, 16, v17
  v_and_b32 v29, 0xffff0000, v17
  v_lshlrev_b32 v30, 16, v101
  v_and_b32 v31, 0xffff0000, v101
  v_pk_add_f32 v[28:29], v[28:29], v[30:31]
  v_cvt_pk_bf16_f32 v17, v28, v29
  v_lshlrev_b32 v28, 16, v18
  v_and_b32 v29, 0xffff0000, v18
  v_lshlrev_b32 v30, 16, v102
  v_and_b32 v31, 0xffff0000, v102
  v_pk_add_f32 v[28:29], v[28:29], v[30:31]
  v_cvt_pk_bf16_f32 v18, v28, v29
  v_lshlrev_b32 v28, 16, v19
  v_and_b32 v29, 0xffff0000, v19
  v_lshlrev_b32 v30, 16, v103
  v_and_b32 v31, 0xffff0000, v103
  v_pk_add_f32 v[28:29], v[28:29], v[30:31]
  v_cvt_pk_bf16_f32 v19, v28, v29
  buffer_store_dwordx4 v[16:19], v109, s[20:23], 0 offen sc1
  v_mov_b32 v24, 0
  v_mov_b32 v25, 0
  s_nop 0
  v_dot2_f32_bf16 v24, v16, v26, v24
  v_dot2_f32_bf16 v25, v16, v16, v25
  v_dot2_f32_bf16 v24, v17, v26, v24
  v_dot2_f32_bf16 v25, v17, v17, v25
  v_dot2_f32_bf16 v24, v18, v26, v24
  v_dot2_f32_bf16 v25, v18, v18, v25
  v_dot2_f32_bf16 v24, v19, v26, v24
  v_dot2_f32_bf16 v25, v19, v19, v25
  s_nop 2
  v_add_f32_dpp v24, v24, v24 quad_perm:[1,0,3,2] row_mask:0xf bank_mask:0xf
  v_add_f32_dpp v25, v25, v25 quad_perm:[1,0,3,2] row_mask:0xf bank_mask:0xf
  s_nop 0
  v_add_f32_dpp v24, v24, v24 quad_perm:[2,3,0,1] row_mask:0xf bank_mask:0xf
  v_add_f32_dpp v25, v25, v25 quad_perm:[2,3,0,1] row_mask:0xf bank_mask:0xf
  s_nop 0
  v_add_f32_dpp v24, v24, v24 row_half_mirror row_mask:0xf bank_mask:0xf
  v_add_f32_dpp v25, v25, v25 row_half_mirror row_mask:0xf bank_mask:0xf
  s_nop 0
  s_mul_i32 s39, s32, 10
  s_add_u32 s39, s39, s33
  s_mul_i32 s39, s39, 1536
  s_lshl_b32 s40, s36, 7
  s_add_u32 s39, s39, s40
  v_lshrrev_b32 v9, 3, v2
  v_lshlrev_b32 v9, 4, v9
  v_add_u32 v9, s39, v9
  v_mov_b32 v12, v24
  v_mov_b32 v13, v25
  v_mov_b32 v14, 0
  v_mov_b32 v15, 0
  s_mov_b32 exec_lo, 0x1010101
  s_mov_b32 exec_hi, 0x1010101
  buffer_store_dwordx4 v[12:15], v9, s[28:31], 0 offen offset:0 sc1
  s_mov_b64 exec, -1
  s_cmp_ge_u32 s36, 3
  s_cbranch_scc1 Lsdone_23
  v_lshlrev_b32 v28, 16, v20
  v_and_b32 v29, 0xffff0000, v20
  v_lshlrev_b32 v30, 16, v104
  v_and_b32 v31, 0xffff0000, v104
  v_pk_add_f32 v[28:29], v[28:29], v[30:31]
  v_cvt_pk_bf16_f32 v20, v28, v29
  v_lshlrev_b32 v28, 16, v21
  v_and_b32 v29, 0xffff0000, v21
  v_lshlrev_b32 v30, 16, v105
  v_and_b32 v31, 0xffff0000, v105
  v_pk_add_f32 v[28:29], v[28:29], v[30:31]
  v_cvt_pk_bf16_f32 v21, v28, v29
  v_lshlrev_b32 v28, 16, v22
  v_and_b32 v29, 0xffff0000, v22
  v_lshlrev_b32 v30, 16, v106
  v_and_b32 v31, 0xffff0000, v106
  v_pk_add_f32 v[28:29], v[28:29], v[30:31]
  v_cvt_pk_bf16_f32 v22, v28, v29
  v_lshlrev_b32 v28, 16, v23
  v_and_b32 v29, 0xffff0000, v23
  v_lshlrev_b32 v30, 16, v107
  v_and_b32 v31, 0xffff0000, v107
  v_pk_add_f32 v[28:29], v[28:29], v[30:31]
  v_cvt_pk_bf16_f32 v23, v28, v29
  buffer_store_dwordx4 v[20:23], v110, s[20:23], 0 offen sc1
  v_mov_b32 v24, 0
  v_mov_b32 v25, 0
  s_nop 0
  v_dot2_f32_bf16 v24, v20, v26, v24
  v_dot2_f32_bf16 v25, v20, v20, v25
  v_dot2_f32_bf16 v24, v21, v26, v24
  v_dot2_f32_bf16 v25, v21, v21, v25
  v_dot2_f32_bf16 v24, v22, v26, v24
  v_dot2_f32_bf16 v25, v22, v22, v25
  v_dot2_f32_bf16 v24, v23, v26, v24
  v_dot2_f32_bf16 v25, v23, v23, v25
  s_nop 2
  v_add_f32_dpp v24, v24, v24 quad_perm:[1,0,3,2] row_mask:0xf bank_mask:0xf
  v_add_f32_dpp v25, v25, v25 quad_perm:[1,0,3,2] row_mask:0xf bank_mask:0xf
  s_nop 0
  v_add_f32_dpp v24, v24, v24 quad_perm:[2,3,0,1] row_mask:0xf bank_mask:0xf
  v_add_f32_dpp v25, v25, v25 quad_perm:[2,3,0,1] row_mask:0xf bank_mask:0xf
  s_nop 0
  v_add_f32_dpp v24, v24, v24 row_half_mirror row_mask:0xf bank_mask:0xf
  v_add_f32_dpp v25, v25, v25 row_half_mirror row_mask:0xf bank_mask:0xf
  s_nop 0
  s_mul_i32 s39, s32, 10
  s_add_u32 s39, s39, s33
  s_mul_i32 s39, s39, 1536
  s_lshl_b32 s40, s36, 7
  s_add_u32 s39, s39, s40
  v_lshrrev_b32 v9, 3, v2
  v_lshlrev_b32 v9, 4, v9
  v_add_u32 v9, s39, v9
  v_mov_b32 v12, v24
  v_mov_b32 v13, v25
  v_mov_b32 v14, 0
  v_mov_b32 v15, 0
  s_mov_b32 exec_lo, 0x1010101
  s_mov_b32 exec_hi, 0x1010101
  buffer_store_dwordx4 v[12:15], v9, s[28:31], 0 offen offset:1024 sc1
  s_mov_b64 exec, -1
Lsdone_23:
  s_mul_i32 s85, s32, 10
  s_add_u32 s85, s85, s33
  s_lshl_b32 s85, s85, 7
  s_add_u32 s85, s85, 0x10000
  s_waitcnt vmcnt(0)
  s_barrier
  s_cmp_eq_u32 s36, 0
  s_cbranch_scc0 Lpub_24
  s_cmp_eq_u32 s85, -1
  s_cbranch_scc1 Lpub_24
  v_mov_b32 v140, s78
  v_mov_b32 v141, s79
  v_mov_b32 v142, s85
  s_mov_b64 exec, 1
  buffer_store_dwordx2 v[140:141], v142, s[88:91], 0 offen sc1
  s_mov_b64 exec, -1
Lpub_24:
Linv_15:
  s_and_b32 s39, s2, 7
  s_lshr_b32 s40, s2, 3
  s_lshl_b32 s39, s39, 5
  s_add_u32 s39, s39, s40
  s_cmp_lt_u32 s39, 243
  s_cselect_b32 s87, 1, 0
  s_cmp_ge_u32 s39, 108
  s_cselect_b32 s40, 108, 0
  s_sub_u32 s41, s39, s40
  s_mul_i32 s33, s41, 16384
  s_lshr_b32 s33, s33, 16
  s_mul_i32 s32, s41, 13108
  s_lshr_b32 s32, s32, 16
  s_cmp_ge_u32 s39, 108
  s_cselect_b32 s33, s32, s33
  s_cselect_b32 s32, 5, 4
  s_mul_i32 s32, s32, s33
  s_sub_u32 s32, s41, s32
  s_cmp_ge_u32 s39, 108
  s_cselect_b32 s40, 4, 0
  s_add_u32 s32, s32, s40
  s_cmp_eq_u32 s87, 0
  s_cbranch_scc1 Linv_26
  s_mul_i32 s34, s32, 228
  s_mul_i32 s35, s33, 64
  s_add_u32 s68, s34, 228
  s_min_u32 s68, s68, 2048
  v_and_b32 v3, 15, v2
  v_lshrrev_b32 v4, 4, v2
  s_lshr_b32 s66, s36, 1
  s_and_b32 s67, s36, 1
  s_lshl_b32 s40, s66, 7
  v_lshrrev_b32 v5, 1, v3
  v_xor_b32 v5, v4, v5
  v_lshlrev_b32 v5, 4, v5
  v_lshl_add_u32 v8, v3, 7, v5
  s_lshl_b32 s39, s40, 7
  v_add_u32 v8, s39, v8
  v_lshrrev_b32 v5, 1, v3
  v_xor_b32 v5, v4, v5
  v_lshlrev_b32 v5, 4, v5
  v_lshl_add_u32 v9, v3, 7, v5
  v_add_u32 v9, 14336, v9
  v_lshrrev_b32 v5, 2, v3
  v_lshl_add_u32 v6, v4, 3, v5
  v_lshlrev_b32 v6, 7, v6
  v_lshrrev_b32 v5, 1, v5
  v_and_b32 v7, 1, v4
  v_lshl_or_b32 v5, v7, 1, v5
  v_lshl_add_u32 v6, v5, 5, v6
  v_and_b32 v5, 3, v3
  v_lshl_add_u32 v10, v5, 3, v6
  s_lshl_b32 s39, s67, 1
  s_add_u32 s39, s39, s66
  s_lshl_b32 s39, s39, 5
  v_xor_b32 v10, s39, v10
  s_lshl_b32 s39, s67, 1
  s_add_u32 s41, s39, s66
  s_lshl_b32 s39, s41, 6
  v_lshlrev_b32 v24, 4, v4
  v_add_u32 v24, s39, v24
  v_add_u32 v24, 143232, v24
  v_xor_b32 v25, 64, v24
  v_lshrrev_b32 v5, 1, v4
  v_and_b32 v6, 7, v3
  v_xor_b32 v5, v5, v6
  v_lshlrev_b32 v5, 4, v5
  v_and_b32 v6, 1, v4
  v_lshl_add_u32 v5, v6, 3, v5
  v_lshl_add_u32 v26, v3, 7, v5
  v_add_u32 v26, 47104, v26
  s_lshl_b32 s39, s41, 5
  v_xor_b32 v26, s39, v26
  v_add_u32 v28, 14336, v26
  s_lshl_b32 s39, s66, 14
  v_add_u32 v26, s39, v26
  v_xor_b32 v27, 32, v26
  s_lshl_b32 s39, s66, 10
  v_lshlrev_b32 v29, 3, v3
  v_add_u32 v30, 142208, v29
  v_add_u32 v29, s39, v29
  v_add_u32 v29, 141312, v29
  s_mov_b32 s37, 0
  v_add_u32 v11, s37, v8
  v_add_u32 v15, s37, v10
  v_add_u32 v13, s37, v9
  v_xor_b32 v12, 64, v11
  v_xor_b32 v16, 32, v15
  v_xor_b32 v14, 64, v13
  s_add_u32 s20, s62, 0x1000000
  s_addc_u32 s21, s63, 0
  s_and_b32 s21, s21, 0xffff
  s_mov_b32 s22, 0x6c0000
  s_mov_b32 s23, 0x20000
  s_mul_i32 s69, s33, 1
  s_mul_i32 s39, s32, 9
  s_add_u32 s69, s69, s39
  s_lshr_b32 s69, s69, 2
  s_mul_i32 s39, s69, 6554
  s_lshr_b32 s39, s39, 16
  s_mul_i32 s39, s39, 10
  s_sub_u32 s69, s69, s39
  s_add_u32 s92, s69, 1
  s_cmp_ge_u32 s92, 10
  s_cselect_b32 s92, 0, s92
  s_mul_i32 s39, s34, 1599
  s_lshr_b32 s39, s39, 17
  s_sub_u32 s40, s68, 1
  s_mul_i32 s40, s40, 1599
  s_lshr_b32 s40, s40, 17
  s_cmp_eq_u32 s36, 0
  s_cbranch_scc0 Lpollskip_27
  v_lshrrev_b32 v140, 1, v2
  v_add_u32 v140, s39, v140
  v_cmp_ge_u32 vcc, s40, v140
  v_mul_u32_u24 v140, 10, v140
  v_and_b32 v141, 1, v2
  s_sub_u32 s41, s92, s69
  v_mul_lo_u32 v141, v141, s41
  v_add_u32 v141, s69, v141
  v_add_u32 v140, v140, v141
  v_lshlrev_b32 v140, 7, v140
  v_add_u32 v140, 65536, v140
  s_and_saveexec_b64 s[80:81], vcc
  s_mov_b32 s38, 0x40000
Lpoll_28:
  buffer_load_dwordx2 v[142:143], v140, s[88:91], 0 offen sc1
  s_waitcnt vmcnt(0)
  v_cmp_ne_u64 vcc, s[78:79], v[142:143]
  s_cbranch_vccz Lpolldone_29
  s_sub_u32 s38, s38, 1
  s_cmp_lg_u32 s38, 0
  s_cbranch_scc1 Lpoll_28
Lpolldone_29:
  s_mov_b64 exec, s[80:81]
Lpollskip_27:
  s_barrier
  s_mul_i32 s39, s34, 1599
  s_lshr_b32 s39, s39, 17
  s_sub_u32 s40, s68, 1
  s_mul_i32 s40, s40, 1599
  s_lshr_b32 s40, s40, 17
  s_mul_i32 s39, s39, 10
  s_add_u32 s40, s40, 1
  s_mul_i32 s40, s40, 10
  s_cmp_eq_u32 s36, 0
  s_cbranch_scc0 Lpollskip_30
  v_add_u32 v140, s39, v2
  v_cmp_gt_u32 vcc, s40, v140
  v_lshlrev_b32 v140, 7, v140
  v_add_u32 v140, 65536, v140
  s_and_saveexec_b64 s[80:81], vcc
  s_mov_b32 s38, 0x40000
Lpoll_31:
  buffer_load_dwordx2 v[142:143], v140, s[88:91], 0 offen sc1
  s_waitcnt vmcnt(0)
  v_cmp_ne_u64 vcc, s[78:79], v[142:143]
  s_cbranch_vccz Lpolldone_32
  s_sub_u32 s38, s38, 1
  s_cmp_lg_u32 s38, 0
  s_cbranch_scc1 Lpoll_31
Lpolldone_32:
  s_mov_b64 exec, s[80:81]
Lpollskip_30:
  s_barrier
  ds_read_b64_tr_b16 a[64:65], v15 offset:30720
  ds_read_b64_tr_b16 a[66:67], v15 offset:31232
  ds_read_b64_tr_b16 a[68:69], v15 offset:38912
  ds_read_b64_tr_b16 a[70:71], v15 offset:39424
  ds_read_b64_tr_b16 a[72:73], v16 offset:30720
  ds_read_b64_tr_b16 a[74:75], v16 offset:31232
  ds_read_b64_tr_b16 a[76:77], v16 offset:38912
  ds_read_b64_tr_b16 a[78:79], v16 offset:39424
  ds_read_b128 a[0:3], v11 offset:0
  ds_read_b128 a[4:7], v11 offset:2048
  ds_read_b128 a[8:11], v11 offset:4096
  ds_read_b128 a[12:15], v11 offset:6144
  ds_read_b128 a[16:19], v11 offset:8192
  ds_read_b128 a[20:23], v11 offset:10240
  ds_read_b128 a[24:27], v11 offset:12288
  ds_read_b128 a[28:31], v13 offset:0
  s_mov_b32 s38, 9
  s_waitcnt lgkmcnt(0)
  v_mfma_f32_16x16x32_bf16 v[32:35], a[64:67], a[0:3], 0
  ds_read_b64_tr_b16 a[80:81], v15 offset:34816
  v_mfma_f32_16x16x32_bf16 v[36:39], a[68:71], a[0:3], 0
  ds_read_b64_tr_b16 a[82:83], v15 offset:35328
  v_mfma_f32_16x16x32_bf16 v[40:43], a[72:75], a[0:3], 0
  ds_read_b64_tr_b16 a[84:85], v15 offset:43008
  v_mfma_f32_16x16x32_bf16 v[44:47], a[76:79], a[0:3], 0
  ds_read_b64_tr_b16 a[86:87], v15 offset:43520
  v_mfma_f32_16x16x32_bf16 v[48:51], a[64:67], a[4:7], 0
  ds_read_b64_tr_b16 a[88:89], v16 offset:34816
  v_mfma_f32_16x16x32_bf16 v[52:55], a[68:71], a[4:7], 0
  ds_read_b64_tr_b16 a[90:91], v16 offset:35328
  v_mfma_f32_16x16x32_bf16 v[56:59], a[72:75], a[4:7], 0
  ds_read_b64_tr_b16 a[92:93], v16 offset:43008
  v_mfma_f32_16x16x32_bf16 v[60:63], a[76:79], a[4:7], 0
  ds_read_b64_tr_b16 a[94:95], v16 offset:43520
  v_mfma_f32_16x16x32_bf16 v[64:67], a[64:67], a[8:11], 0
  ds_read_b128 a[32:35], v12 offset:0
  v_mfma_f32_16x16x32_bf16 v[68:71], a[68:71], a[8:11], 0
  ds_read_b128 a[36:39], v12 offset:2048
  v_mfma_f32_16x16x32_bf16 v[72:75], a[72:75], a[8:11], 0
  ds_read_b128 a[40:43], v12 offset:4096
  v_mfma_f32_16x16x32_bf16 v[76:79], a[76:79], a[8:11], 0
  ds_read_b128 a[44:47], v12 offset:6144
  v_mfma_f32_16x16x32_bf16 v[80:83], a[64:67], a[12:15], 0
  ds_read_b128 a[48:51], v12 offset:8192
  v_mfma_f32_16x16x32_bf16 v[84:87], a[68:71], a[12:15], 0
  ds_read_b128 a[52:55], v12 offset:10240
  v_mfma_f32_16x16x32_bf16 v[88:91], a[72:75], a[12:15], 0
  ds_read_b128 a[56:59], v12 offset:12288
  v_mfma_f32_16x16x32_bf16 v[92:95], a[76:79], a[12:15], 0
  ds_read_b128 a[60:63], v14 offset:0
  s_add_u32 s37, s37, 47104
  v_mfma_f32_16x16x32_bf16 v[96:99], a[64:67], a[16:19], 0
  s_cmp_ge_u32 s37, 141312
  s_cselect_b32 s37, 0, s37
  v_mfma_f32_16x16x32_bf16 v[100:103], a[68:71], a[16:19], 0
  v_add_u32 v11, s37, v8
  v_add_u32 v15, s37, v10
  v_mfma_f32_16x16x32_bf16 v[104:107], a[72:75], a[16:19], 0
  v_add_u32 v13, s37, v9
  v_xor_b32 v12, 64, v11
  v_mfma_f32_16x16x32_bf16 v[108:111], a[76:79], a[16:19], 0
  v_xor_b32 v16, 32, v15
  v_xor_b32 v14, 64, v13
  v_mfma_f32_16x16x32_bf16 v[112:115], a[64:67], a[20:23], 0
  v_mfma_f32_16x16x32_bf16 v[116:119], a[68:71], a[20:23], 0
  v_mfma_f32_16x16x32_bf16 v[120:123], a[72:75], a[20:23], 0
  v_mfma_f32_16x16x32_bf16 v[124:127], a[76:79], a[20:23], 0
  v_mfma_f32_16x16x32_bf16 v[128:131], a[64:67], a[24:27], 0
  v_mfma_f32_16x16x32_bf16 v[132:135], a[68:71], a[24:27], 0
  v_mfma_f32_16x16x32_bf16 v[136:139], a[72:75], a[24:27], 0
  v_mfma_f32_16x16x32_bf16 v[140:143], a[76:79], a[24:27], 0
  v_mfma_f32_16x16x32_bf16 v[144:147], a[64:67], a[28:31], 0
  v_mfma_f32_16x16x32_bf16 v[148:151], a[68:71], a[28:31], 0
.p2align 6
Lcloop_33:
  s_waitcnt lgkmcnt(0)
  s_barrier
  v_mfma_f32_16x16x32_bf16 v[32:35], a[80:83], a[32:35], v[32:35]
  ds_read_b64_tr_b16 a[64:65], v15 offset:30720
  v_mfma_f32_16x16x32_bf16 v[36:39], a[84:87], a[32:35], v[36:39]
  ds_read_b64_tr_b16 a[66:67], v15 offset:31232
  v_mfma_f32_16x16x32_bf16 v[40:43], a[88:91], a[32:35], v[40:43]
  ds_read_b64_tr_b16 a[68:69], v15 offset:38912
  v_mfma_f32_16x16x32_bf16 v[44:47], a[92:95], a[32:35], v[44:47]
  ds_read_b64_tr_b16 a[70:71], v15 offset:39424
  v_mfma_f32_16x16x32_bf16 v[48:51], a[80:83], a[36:39], v[48:51]
  ds_read_b64_tr_b16 a[72:73], v16 offset:30720
  v_mfma_f32_16x16x32_bf16 v[52:55], a[84:87], a[36:39], v[52:55]
  ds_read_b64_tr_b16 a[74:75], v16 offset:31232
  v_mfma_f32_16x16x32_bf16 v[56:59], a[88:91], a[36:39], v[56:59]
  ds_read_b64_tr_b16 a[76:77], v16 offset:38912
  v_mfma_f32_16x16x32_bf16 v[60:63], a[92:95], a[36:39], v[60:63]
  ds_read_b64_tr_b16 a[78:79], v16 offset:39424
  v_mfma_f32_16x16x32_bf16 v[64:67], a[80:83], a[40:43], v[64:67]
  ds_read_b128 a[0:3], v11 offset:0
  v_mfma_f32_16x16x32_bf16 v[68:71], a[84:87], a[40:43], v[68:71]
  ds_read_b128 a[4:7], v11 offset:2048
  v_mfma_f32_16x16x32_bf16 v[72:75], a[88:91], a[40:43], v[72:75]
  ds_read_b128 a[8:11], v11 offset:4096
  v_mfma_f32_16x16x32_bf16 v[76:79], a[92:95], a[40:43], v[76:79]
  ds_read_b128 a[12:15], v11 offset:6144
  v_mfma_f32_16x16x32_bf16 v[80:83], a[80:83], a[44:47], v[80:83]
  ds_read_b128 a[16:19], v11 offset:8192
  v_mfma_f32_16x16x32_bf16 v[84:87], a[84:87], a[44:47], v[84:87]
  ds_read_b128 a[20:23], v11 offset:10240
  v_mfma_f32_16x16x32_bf16 v[88:91], a[88:91], a[44:47], v[88:91]
  ds_read_b128 a[24:27], v11 offset:12288
  v_mfma_f32_16x16x32_bf16 v[92:95], a[92:95], a[44:47], v[92:95]
  ds_read_b128 a[28:31], v13 offset:0
  s_sub_u32 s38, s38, 1
  v_mfma_f32_16x16x32_bf16 v[96:99], a[80:83], a[48:51], v[96:99]
  v_mfma_f32_16x16x32_bf16 v[100:103], a[84:87], a[48:51], v[100:103]
  v_mfma_f32_16x16x32_bf16 v[104:107], a[88:91], a[48:51], v[104:107]
  v_mfma_f32_16x16x32_bf16 v[108:111], a[92:95], a[48:51], v[108:111]
  v_mfma_f32_16x16x32_bf16 v[112:115], a[80:83], a[52:55], v[112:115]
  v_mfma_f32_16x16x32_bf16 v[116:119], a[84:87], a[52:55], v[116:119]
  v_mfma_f32_16x16x32_bf16 v[120:123], a[88:91], a[52:55], v[120:123]
  v_mfma_f32_16x16x32_bf16 v[124:127], a[92:95], a[52:55], v[124:127]
  v_mfma_f32_16x16x32_bf16 v[128:131], a[80:83], a[56:59], v[128:131]
  v_mfma_f32_16x16x32_bf16 v[132:135], a[84:87], a[56:59], v[132:135]
  v_mfma_f32_16x16x32_bf16 v[136:139], a[88:91], a[56:59], v[136:139]
  v_mfma_f32_16x16x32_bf16 v[140:143], a[92:95], a[56:59], v[140:143]
  v_mfma_f32_16x16x32_bf16 v[144:147], a[80:83], a[60:63], v[144:147]
  v_mfma_f32_16x16x32_bf16 v[148:151], a[84:87], a[60:63], v[148:151]
  s_waitcnt lgkmcnt(0)
  v_mfma_f32_16x16x32_bf16 v[32:35], a[64:67], a[0:3], v[32:35]
  ds_read_b64_tr_b16 a[80:81], v15 offset:34816
  v_mfma_f32_16x16x32_bf16 v[36:39], a[68:71], a[0:3], v[36:39]
  ds_read_b64_tr_b16 a[82:83], v15 offset:35328
  v_mfma_f32_16x16x32_bf16 v[40:43], a[72:75], a[0:3], v[40:43]
  ds_read_b64_tr_b16 a[84:85], v15 offset:43008
  v_mfma_f32_16x16x32_bf16 v[44:47], a[76:79], a[0:3], v[44:47]
  ds_read_b64_tr_b16 a[86:87], v15 offset:43520
  v_mfma_f32_16x16x32_bf16 v[48:51], a[64:67], a[4:7], v[48:51]
  ds_read_b64_tr_b16 a[88:89], v16 offset:34816
  v_mfma_f32_16x16x32_bf16 v[52:55], a[68:71], a[4:7], v[52:55]
  ds_read_b64_tr_b16 a[90:91], v16 offset:35328
  v_mfma_f32_16x16x32_bf16 v[56:59], a[72:75], a[4:7], v[56:59]
  ds_read_b64_tr_b16 a[92:93], v16 offset:43008
  v_mfma_f32_16x16x32_bf16 v[60:63], a[76:79], a[4:7], v[60:63]
  ds_read_b64_tr_b16 a[94:95], v16 offset:43520
  v_mfma_f32_16x16x32_bf16 v[64:67], a[64:67], a[8:11], v[64:67]
  ds_read_b128 a[32:35], v12 offset:0
  v_mfma_f32_16x16x32_bf16 v[68:71], a[68:71], a[8:11], v[68:71]
  ds_read_b128 a[36:39], v12 offset:2048
  v_mfma_f32_16x16x32_bf16 v[72:75], a[72:75], a[8:11], v[72:75]
  ds_read_b128 a[40:43], v12 offset:4096
  v_mfma_f32_16x16x32_bf16 v[76:79], a[76:79], a[8:11], v[76:79]
  ds_read_b128 a[44:47], v12 offset:6144
  v_mfma_f32_16x16x32_bf16 v[80:83], a[64:67], a[12:15], v[80:83]
  ds_read_b128 a[48:51], v12 offset:8192
  v_mfma_f32_16x16x32_bf16 v[84:87], a[68:71], a[12:15], v[84:87]
  ds_read_b128 a[52:55], v12 offset:10240
  v_mfma_f32_16x16x32_bf16 v[88:91], a[72:75], a[12:15], v[88:91]
  ds_read_b128 a[56:59], v12 offset:12288
  v_mfma_f32_16x16x32_bf16 v[92:95], a[76:79], a[12:15], v[92:95]
  ds_read_b128 a[60:63], v14 offset:0
  s_add_u32 s37, s37, 47104
  v_mfma_f32_16x16x32_bf16 v[96:99], a[64:67], a[16:19], v[96:99]
  s_cmp_ge_u32 s37, 141312
  s_cselect_b32 s37, 0, s37
  v_mfma_f32_16x16x32_bf16 v[100:103], a[68:71], a[16:19], v[100:103]
  v_add_u32 v11, s37, v8
  v_add_u32 v15, s37, v10
  v_mfma_f32_16x16x32_bf16 v[104:107], a[72:75], a[16:19], v[104:107]
  v_add_u32 v13, s37, v9
  v_xor_b32 v12, 64, v11
  v_mfma_f32_16x16x32_bf16 v[108:111], a[76:79], a[16:19], v[108:111]
  v_xor_b32 v16, 32, v15
  v_xor_b32 v14, 64, v13
  v_mfma_f32_16x16x32_bf16 v[112:115], a[64:67], a[20:23], v[112:115]
  s_cmp_lg_u32 s38, 0
  v_mfma_f32_16x16x32_bf16 v[116:119], a[68:71], a[20:23], v[116:119]
  v_mfma_f32_16x16x32_bf16 v[120:123], a[72:75], a[20:23], v[120:123]
  v_mfma_f32_16x16x32_bf16 v[124:127], a[76:79], a[20:23], v[124:127]
  v_mfma_f32_16x16x32_bf16 v[128:131], a[64:67], a[24:27], v[128:131]
  v_mfma_f32_16x16x32_bf16 v[132:135], a[68:71], a[24:27], v[132:135]
  v_mfma_f32_16x16x32_bf16 v[136:139], a[72:75], a[24:27], v[136:139]
  v_mfma_f32_16x16x32_bf16 v[140:143], a[76:79], a[24:27], v[140:143]
  v_mfma_f32_16x16x32_bf16 v[144:147], a[64:67], a[28:31], v[144:147]
  v_mfma_f32_16x16x32_bf16 v[148:151], a[68:71], a[28:31], v[148:151]
  s_cbranch_scc1 Lcloop_33
  s_waitcnt lgkmcnt(0)
  v_mfma_f32_16x16x32_bf16 v[32:35], a[80:83], a[32:35], v[32:35]
  v_mfma_f32_16x16x32_bf16 v[36:39], a[84:87], a[32:35], v[36:39]
  v_mfma_f32_16x16x32_bf16 v[40:43], a[88:91], a[32:35], v[40:43]
  v_mfma_f32_16x16x32_bf16 v[44:47], a[92:95], a[32:35], v[44:47]
  v_mfma_f32_16x16x32_bf16 v[48:51], a[80:83], a[36:39], v[48:51]
  v_mfma_f32_16x16x32_bf16 v[52:55], a[84:87], a[36:39], v[52:55]
  v_mfma_f32_16x16x32_bf16 v[56:59], a[88:91], a[36:39], v[56:59]
  v_mfma_f32_16x16x32_bf16 v[60:63], a[92:95], a[36:39], v[60:63]
  v_mfma_f32_16x16x32_bf16 v[64:67], a[80:83], a[40:43], v[64:67]
  v_mfma_f32_16x16x32_bf16 v[68:71], a[84:87], a[40:43], v[68:71]
  v_mfma_f32_16x16x32_bf16 v[72:75], a[88:91], a[40:43], v[72:75]
  v_mfma_f32_16x16x32_bf16 v[76:79], a[92:95], a[40:43], v[76:79]
  v_mfma_f32_16x16x32_bf16 v[80:83], a[80:83], a[44:47], v[80:83]
  v_mfma_f32_16x16x32_bf16 v[84:87], a[84:87], a[44:47], v[84:87]
  v_mfma_f32_16x16x32_bf16 v[88:91], a[88:91], a[44:47], v[88:91]
  v_mfma_f32_16x16x32_bf16 v[92:95], a[92:95], a[44:47], v[92:95]
  v_mfma_f32_16x16x32_bf16 v[96:99], a[80:83], a[48:51], v[96:99]
  v_mfma_f32_16x16x32_bf16 v[100:103], a[84:87], a[48:51], v[100:103]
  v_mfma_f32_16x16x32_bf16 v[104:107], a[88:91], a[48:51], v[104:107]
  v_mfma_f32_16x16x32_bf16 v[108:111], a[92:95], a[48:51], v[108:111]
  v_mfma_f32_16x16x32_bf16 v[112:115], a[80:83], a[52:55], v[112:115]
  v_mfma_f32_16x16x32_bf16 v[116:119], a[84:87], a[52:55], v[116:119]
  v_mfma_f32_16x16x32_bf16 v[120:123], a[88:91], a[52:55], v[120:123]
  v_mfma_f32_16x16x32_bf16 v[124:127], a[92:95], a[52:55], v[124:127]
  v_mfma_f32_16x16x32_bf16 v[128:131], a[80:83], a[56:59], v[128:131]
  v_mfma_f32_16x16x32_bf16 v[132:135], a[84:87], a[56:59], v[132:135]
  v_mfma_f32_16x16x32_bf16 v[136:139], a[88:91], a[56:59], v[136:139]
  v_mfma_f32_16x16x32_bf16 v[140:143], a[92:95], a[56:59], v[140:143]
  v_mfma_f32_16x16x32_bf16 v[144:147], a[80:83], a[60:63], v[144:147]
  v_mfma_f32_16x16x32_bf16 v[148:151], a[84:87], a[60:63], v[148:151]
  s_nop 7
L_epi3_start:
  s_cmp_eq_u32 s66, 1
  s_cbranch_scc0 Lnocs_34
  s_mov_b32 exec_lo, 0x80008000
  s_mov_b32 exec_hi, 0x80008000
  ds_write_b128 v24, v[128:131] offset:0
  ds_write_b128 v24, v[132:135] offset:256
  ds_write_b128 v25, v[136:139] offset:0
  ds_write_b128 v25, v[140:143] offset:256
  s_mov_b64 exec, -1
Lnocs_34:
  s_waitcnt lgkmcnt(0)
  s_barrier
  ds_read_b128 v[8:11], v24 offset:0
  ds_read_b128 v[12:15], v24 offset:256
  ds_read_b128 v[152:155], v25 offset:0
  ds_read_b128 v[156:159], v25 offset:256
  ds_read_b64 v[16:17], v29 offset:0
  ds_read_b64 v[18:19], v29 offset:128
  ds_read_b64 v[20:21], v29 offset:256
  ds_read_b64 v[22:23], v29 offset:384
  s_waitcnt lgkmcnt(0)
  v_mul_f32 v17, v17, v17
  v_pk_fma_f32 v[32:33], v[8:9], v[16:17], v[32:33] op_sel_hi:[1,0,1] neg_lo:[0,1,0] neg_hi:[0,1,0]
  v_pk_fma_f32 v[36:37], v[12:13], v[16:17], v[36:37] op_sel_hi:[1,0,1] neg_lo:[0,1,0] neg_hi:[0,1,0]
  v_pk_fma_f32 v[34:35], v[10:11], v[16:17], v[34:35] op_sel_hi:[1,0,1] neg_lo:[0,1,0] neg_hi:[0,1,0]
  v_pk_fma_f32 v[38:39], v[14:15], v[16:17], v[38:39] op_sel_hi:[1,0,1] neg_lo:[0,1,0] neg_hi:[0,1,0]
  v_pk_mul_f32 v[32:33], v[32:33], v[36:37]
  v_pk_mul_f32 v[34:35], v[34:35], v[38:39]
  v_pk_mul_f32 v[32:33], v[32:33], v[16:17] op_sel:[0,1] op_sel_hi:[1,1]
  v_pk_mul_f32 v[34:35], v[34:35], v[16:17] op_sel:[0,1] op_sel_hi:[1,1]
  v_cvt_pk_bf16_f32 v32, v32, v33
  v_cvt_pk_bf16_f32 v33, v34, v35
  ds_write_b64 v26, v[32:33] offset:0
  v_pk_fma_f32 v[40:41], v[152:153], v[16:17], v[40:41] op_sel_hi:[1,0,1] neg_lo:[0,1,0] neg_hi:[0,1,0]
  v_pk_fma_f32 v[44:45], v[156:157], v[16:17], v[44:45] op_sel_hi:[1,0,1] neg_lo:[0,1,0] neg_hi:[0,1,0]
  v_pk_fma_f32 v[42:43], v[154:155], v[16:17], v[42:43] op_sel_hi:[1,0,1] neg_lo:[0,1,0] neg_hi:[0,1,0]
  v_pk_fma_f32 v[46:47], v[158:159], v[16:17], v[46:47] op_sel_hi:[1,0,1] neg_lo:[0,1,0] neg_hi:[0,1,0]
  v_pk_mul_f32 v[40:41], v[40:41], v[44:45]
  v_pk_mul_f32 v[42:43], v[42:43], v[46:47]
  v_pk_mul_f32 v[40:41], v[40:41], v[16:17] op_sel:[0,1] op_sel_hi:[1,1]
  v_pk_mul_f32 v[42:43], v[42:43], v[16:17] op_sel:[0,1] op_sel_hi:[1,1]
  v_cvt_pk_bf16_f32 v40, v40, v41
  v_cvt_pk_bf16_f32 v41, v42, v43
  ds_write_b64 v27, v[40:41] offset:0
  ds_read_b64 v[16:17], v29 offset:512
  v_mul_f32 v19, v19, v19
  v_pk_fma_f32 v[48:49], v[8:9], v[18:19], v[48:49] op_sel_hi:[1,0,1] neg_lo:[0,1,0] neg_hi:[0,1,0]
  v_pk_fma_f32 v[52:53], v[12:13], v[18:19], v[52:53] op_sel_hi:[1,0,1] neg_lo:[0,1,0] neg_hi:[0,1,0]
  v_pk_fma_f32 v[50:51], v[10:11], v[18:19], v[50:51] op_sel_hi:[1,0,1] neg_lo:[0,1,0] neg_hi:[0,1,0]
  v_pk_fma_f32 v[54:55], v[14:15], v[18:19], v[54:55] op_sel_hi:[1,0,1] neg_lo:[0,1,0] neg_hi:[0,1,0]
  v_pk_mul_f32 v[48:49], v[48:49], v[52:53]
  v_pk_mul_f32 v[50:51], v[50:51], v[54:55]
  v_pk_mul_f32 v[48:49], v[48:49], v[18:19] op_sel:[0,1] op_sel_hi:[1,1]
  v_pk_mul_f32 v[50:51], v[50:51], v[18:19] op_sel:[0,1] op_sel_hi:[1,1]
  v_cvt_pk_bf16_f32 v48, v48, v49
  v_cvt_pk_bf16_f32 v49, v50, v51
  ds_write_b64 v26, v[48:49] offset:2048
  v_pk_fma_f32 v[56:57], v[152:153], v[18:19], v[56:57] op_sel_hi:[1,0,1] neg_lo:[0,1,0] neg_hi:[0,1,0]
  v_pk_fma_f32 v[60:61], v[156:157], v[18:19], v[60:61] op_sel_hi:[1,0,1] neg_lo:[0,1,0] neg_hi:[0,1,0]
  v_pk_fma_f32 v[58:59], v[154:155], v[18:19], v[58:59] op_sel_hi:[1,0,1] neg_lo:[0,1,0] neg_hi:[0,1,0]
  v_pk_fma_f32 v[62:63], v[158:159], v[18:19], v[62:63] op_sel_hi:[1,0,1] neg_lo:[0,1,0] neg_hi:[0,1,0]
  v_pk_mul_f32 v[56:57], v[56:57], v[60:61]
  v_pk_mul_f32 v[58:59], v[58:59], v[62:63]
  v_pk_mul_f32 v[56:57], v[56:57], v[18:19] op_sel:[0,1] op_sel_hi:[1,1]
  v_pk_mul_f32 v[58:59], v[58:59], v[18:19] op_sel:[0,1] op_sel_hi:[1,1]
  v_cvt_pk_bf16_f32 v56, v56, v57
  v_cvt_pk_bf16_f32 v57, v58, v59
  ds_write_b64 v27, v[56:57] offset:2048
  ds_read_b64 v[18:19], v29 offset:640
  v_mul_f32 v21, v21, v21
  v_pk_fma_f32 v[64:65], v[8:9], v[20:21], v[64:65] op_sel_hi:[1,0,1] neg_lo:[0,1,0] neg_hi:[0,1,0]
  v_pk_fma_f32 v[68:69], v[12:13], v[20:21], v[68:69] op_sel_hi:[1,0,1] neg_lo:[0,1,0] neg_hi:[0,1,0]
  v_pk_fma_f32 v[66:67], v[10:11], v[20:21], v[66:67] op_sel_hi:[1,0,1] neg_lo:[0,1,0] neg_hi:[0,1,0]
  v_pk_fma_f32 v[70:71], v[14:15], v[20:21], v[70:71] op_sel_hi:[1,0,1] neg_lo:[0,1,0] neg_hi:[0,1,0]
  v_pk_mul_f32 v[64:65], v[64:65], v[68:69]
  v_pk_mul_f32 v[66:67], v[66:67], v[70:71]
  v_pk_mul_f32 v[64:65], v[64:65], v[20:21] op_sel:[0,1] op_sel_hi:[1,1]
  v_pk_mul_f32 v[66:67], v[66:67], v[20:21] op_sel:[0,1] op_sel_hi:[1,1]
  v_cvt_pk_bf16_f32 v64, v64, v65
  v_cvt_pk_bf16_f32 v65, v66, v67
  ds_write_b64 v26, v[64:65] offset:4096
  v_pk_fma_f32 v[72:73], v[152:153], v[20:21], v[72:73] op_sel_hi:[1,0,1] neg_lo:[0,1,0] neg_hi:[0,1,0]
  v_pk_fma_f32 v[76:77], v[156:157], v[20:21], v[76:77] op_sel_hi:[1,0,1] neg_lo:[0,1,0] neg_hi:[0,1,0]
  v_pk_fma_f32 v[74:75], v[154:155], v[20:21], v[74:75] op_sel_hi:[1,0,1] neg_lo:[0,1,0] neg_hi:[0,1,0]
  v_pk_fma_f32 v[78:79], v[158:159], v[20:21], v[78:79] op_sel_hi:[1,0,1] neg_lo:[0,1,0] neg_hi:[0,1,0]
  v_pk_mul_f32 v[72:73], v[72:73], v[76:77]
  v_pk_mul_f32 v[74:75], v[74:75], v[78:79]
  v_pk_mul_f32 v[72:73], v[72:73], v[20:21] op_sel:[0,1] op_sel_hi:[1,1]
  v_pk_mul_f32 v[74:75], v[74:75], v[20:21] op_sel:[0,1] op_sel_hi:[1,1]
  v_cvt_pk_bf16_f32 v72, v72, v73
  v_cvt_pk_bf16_f32 v73, v74, v75
  ds_write_b64 v27, v[72:73] offset:4096
  ds_read_b64 v[20:21], v29 offset:768
  v_mul_f32 v23, v23, v23
  v_pk_fma_f32 v[80:81], v[8:9], v[22:23], v[80:81] op_sel_hi:[1,0,1] neg_lo:[0,1,0] neg_hi:[0,1,0]
  v_pk_fma_f32 v[84:85], v[12:13], v[22:23], v[84:85] op_sel_hi:[1,0,1] neg_lo:[0,1,0] neg_hi:[0,1,0]
  v_pk_fma_f32 v[82:83], v[10:11], v[22:23], v[82:83] op_sel_hi:[1,0,1] neg_lo:[0,1,0] neg_hi:[0,1,0]
  v_pk_fma_f32 v[86:87], v[14:15], v[22:23], v[86:87] op_sel_hi:[1,0,1] neg_lo:[0,1,0] neg_hi:[0,1,0]
  v_pk_mul_f32 v[80:81], v[80:81], v[84:85]
  v_pk_mul_f32 v[82:83], v[82:83], v[86:87]
  v_pk_mul_f32 v[80:81], v[80:81], v[22:23] op_sel:[0,1] op_sel_hi:[1,1]
  v_pk_mul_f32 v[82:83], v[82:83], v[22:23] op_sel:[0,1] op_sel_hi:[1,1]
  v_cvt_pk_bf16_f32 v80, v80, v81
  v_cvt_pk_bf16_f32 v81, v82, v83
  ds_write_b64 v26, v[80:81] offset:6144
  v_pk_fma_f32 v[88:89], v[152:153], v[22:23], v[88:89] op_sel_hi:[1,0,1] neg_lo:[0,1,0] neg_hi:[0,1,0]
  v_pk_fma_f32 v[92:93], v[156:157], v[22:23], v[92:93] op_sel_hi:[1,0,1] neg_lo:[0,1,0] neg_hi:[0,1,0]
  v_pk_fma_f32 v[90:91], v[154:155], v[22:23], v[90:91] op_sel_hi:[1,0,1] neg_lo:[0,1,0] neg_hi:[0,1,0]
  v_pk_fma_f32 v[94:95], v[158:159], v[22:23], v[94:95] op_sel_hi:[1,0,1] neg_lo:[0,1,0] neg_hi:[0,1,0]
  v_pk_mul_f32 v[88:89], v[88:89], v[92:93]
  v_pk_mul_f32 v[90:91], v[90:91], v[94:95]
  v_pk_mul_f32 v[88:89], v[88:89], v[22:23] op_sel:[0,1] op_sel_hi:[1,1]
  v_pk_mul_f32 v[90:91], v[90:91], v[22:23] op_sel:[0,1] op_sel_hi:[1,1]
  v_cvt_pk_bf16_f32 v88, v88, v89
  v_cvt_pk_bf16_f32 v89, v90, v91
  ds_write_b64 v27, v[88:89] offset:6144
  ds_read_b64 v[22:23], v30
  s_waitcnt lgkmcnt(0)
  s_barrier
  v_mul_f32 v17, v17, v17
  v_pk_fma_f32 v[96:97], v[8:9], v[16:17], v[96:97] op_sel_hi:[1,0,1] neg_lo:[0,1,0] neg_hi:[0,1,0]
  v_pk_fma_f32 v[100:101], v[12:13], v[16:17], v[100:101] op_sel_hi:[1,0,1] neg_lo:[0,1,0] neg_hi:[0,1,0]
  v_pk_fma_f32 v[98:99], v[10:11], v[16:17], v[98:99] op_sel_hi:[1,0,1] neg_lo:[0,1,0] neg_hi:[0,1,0]
  v_pk_fma_f32 v[102:103], v[14:15], v[16:17], v[102:103] op_sel_hi:[1,0,1] neg_lo:[0,1,0] neg_hi:[0,1,0]
  v_pk_mul_f32 v[96:97], v[96:97], v[100:101]
  v_pk_mul_f32 v[98:99], v[98:99], v[102:103]
  v_pk_mul_f32 v[96:97], v[96:97], v[16:17] op_sel:[0,1] op_sel_hi:[1,1]
  v_pk_mul_f32 v[98:99], v[98:99], v[16:17] op_sel:[0,1] op_sel_hi:[1,1]
  v_cvt_pk_bf16_f32 v96, v96, v97
  v_cvt_pk_bf16_f32 v97, v98, v99
  ds_write_b64 v26, v[96:97] offset:8192
  v_pk_fma_f32 v[104:105], v[152:153], v[16:17], v[104:105] op_sel_hi:[1,0,1] neg_lo:[0,1,0] neg_hi:[0,1,0]
  v_pk_fma_f32 v[108:109], v[156:157], v[16:17], v[108:109] op_sel_hi:[1,0,1] neg_lo:[0,1,0] neg_hi:[0,1,0]
  v_pk_fma_f32 v[106:107], v[154:155], v[16:17], v[106:107] op_sel_hi:[1,0,1] neg_lo:[0,1,0] neg_hi:[0,1,0]
  v_pk_fma_f32 v[110:111], v[158:159], v[16:17], v[110:111] op_sel_hi:[1,0,1] neg_lo:[0,1,0] neg_hi:[0,1,0]
  v_pk_mul_f32 v[104:105], v[104:105], v[108:109]
  v_pk_mul_f32 v[106:107], v[106:107], v[110:111]
  v_pk_mul_f32 v[104:105], v[104:105], v[16:17] op_sel:[0,1] op_sel_hi:[1,1]
  v_pk_mul_f32 v[106:107], v[106:107], v[16:17] op_sel:[0,1] op_sel_hi:[1,1]
  v_cvt_pk_bf16_f32 v104, v104, v105
  v_cvt_pk_bf16_f32 v105, v106, v107
  ds_write_b64 v27, v[104:105] offset:8192
  v_mul_f32 v19, v19, v19
  v_pk_fma_f32 v[112:113], v[8:9], v[18:19], v[112:113] op_sel_hi:[1,0,1] neg_lo:[0,1,0] neg_hi:[0,1,0]
  v_pk_fma_f32 v[116:117], v[12:13], v[18:19], v[116:117] op_sel_hi:[1,0,1] neg_lo:[0,1,0] neg_hi:[0,1,0]
  v_pk_fma_f32 v[114:115], v[10:11], v[18:19], v[114:115] op_sel_hi:[1,0,1] neg_lo:[0,1,0] neg_hi:[0,1,0]
  v_pk_fma_f32 v[118:119], v[14:15], v[18:19], v[118:119] op_sel_hi:[1,0,1] neg_lo:[0,1,0] neg_hi:[0,1,0]
  v_pk_mul_f32 v[112:113], v[112:113], v[116:117]
  v_pk_mul_f32 v[114:115], v[114:115], v[118:119]
  v_pk_mul_f32 v[112:113], v[112:113], v[18:19] op_sel:[0,1] op_sel_hi:[1,1]
  v_pk_mul_f32 v[114:115], v[114:115], v[18:19] op_sel:[0,1] op_sel_hi:[1,1]
  v_cvt_pk_bf16_f32 v112, v112, v113
  v_cvt_pk_bf16_f32 v113, v114, v115
  ds_write_b64 v26, v[112:113] offset:10240
  v_pk_fma_f32 v[120:121], v[152:153], v[18:19], v[120:121] op_sel_hi:[1,0,1] neg_lo:[0,1,0] neg_hi:[0,1,0]
  v_pk_fma_f32 v[124:125], v[156:157], v[18:19], v[124:125] op_sel_hi:[1,0,1] neg_lo:[0,1,0] neg_hi:[0,1,0]
  v_pk_fma_f32 v[122:123], v[154:155], v[18:19], v[122:123] op_sel_hi:[1,0,1] neg_lo:[0,1,0] neg_hi:[0,1,0]
  v_pk_fma_f32 v[126:127], v[158:159], v[18:19], v[126:127] op_sel_hi:[1,0,1] neg_lo:[0,1,0] neg_hi:[0,1,0]
  v_pk_mul_f32 v[120:121], v[120:121], v[124:125]
  v_pk_mul_f32 v[122:123], v[122:123], v[126:127]
  v_pk_mul_f32 v[120:121], v[120:121], v[18:19] op_sel:[0,1] op_sel_hi:[1,1]
  v_pk_mul_f32 v[122:123], v[122:123], v[18:19] op_sel:[0,1] op_sel_hi:[1,1]
  v_cvt_pk_bf16_f32 v120, v120, v121
  v_cvt_pk_bf16_f32 v121, v122, v123
  ds_write_b64 v27, v[120:121] offset:10240
  v_mul_f32 v21, v21, v21
  v_pk_fma_f32 v[128:129], v[8:9], v[20:21], v[128:129] op_sel_hi:[1,0,1] neg_lo:[0,1,0] neg_hi:[0,1,0]
  v_pk_fma_f32 v[132:133], v[12:13], v[20:21], v[132:133] op_sel_hi:[1,0,1] neg_lo:[0,1,0] neg_hi:[0,1,0]
  v_pk_fma_f32 v[130:131], v[10:11], v[20:21], v[130:131] op_sel_hi:[1,0,1] neg_lo:[0,1,0] neg_hi:[0,1,0]
  v_pk_fma_f32 v[134:135], v[14:15], v[20:21], v[134:135] op_sel_hi:[1,0,1] neg_lo:[0,1,0] neg_hi:[0,1,0]
  v_pk_mul_f32 v[128:129], v[128:129], v[132:133]
  v_pk_mul_f32 v[130:131], v[130:131], v[134:135]
  v_pk_mul_f32 v[128:129], v[128:129], v[20:21] op_sel:[0,1] op_sel_hi:[1,1]
  v_pk_mul_f32 v[130:131], v[130:131], v[20:21] op_sel:[0,1] op_sel_hi:[1,1]
  v_cvt_pk_bf16_f32 v128, v128, v129
  v_cvt_pk_bf16_f32 v129, v130, v131
  ds_write_b64 v26, v[128:129] offset:12288
  v_pk_fma_f32 v[136:137], v[152:153], v[20:21], v[136:137] op_sel_hi:[1,0,1] neg_lo:[0,1,0] neg_hi:[0,1,0]
  v_pk_fma_f32 v[140:141], v[156:157], v[20:21], v[140:141] op_sel_hi:[1,0,1] neg_lo:[0,1,0] neg_hi:[0,1,0]
  v_pk_fma_f32 v[138:139], v[154:155], v[20:21], v[138:139] op_sel_hi:[1,0,1] neg_lo:[0,1,0] neg_hi:[0,1,0]
  v_pk_fma_f32 v[142:143], v[158:159], v[20:21], v[142:143] op_sel_hi:[1,0,1] neg_lo:[0,1,0] neg_hi:[0,1,0]
  v_pk_mul_f32 v[136:137], v[136:137], v[140:141]
  v_pk_mul_f32 v[138:139], v[138:139], v[142:143]
  v_pk_mul_f32 v[136:137], v[136:137], v[20:21] op_sel:[0,1] op_sel_hi:[1,1]
  v_pk_mul_f32 v[138:139], v[138:139], v[20:21] op_sel:[0,1] op_sel_hi:[1,1]
  v_cvt_pk_bf16_f32 v136, v136, v137
  v_cvt_pk_bf16_f32 v137, v138, v139
  ds_write_b64 v27, v[136:137] offset:12288
  v_mul_f32 v23, v23, v23
  v_pk_fma_f32 v[144:145], v[8:9], v[22:23], v[144:145] op_sel_hi:[1,0,1] neg_lo:[0,1,0] neg_hi:[0,1,0]
  v_pk_fma_f32 v[148:149], v[12:13], v[22:23], v[148:149] op_sel_hi:[1,0,1] neg_lo:[0,1,0] neg_hi:[0,1,0]
  v_pk_fma_f32 v[146:147], v[10:11], v[22:23], v[146:147] op_sel_hi:[1,0,1] neg_lo:[0,1,0] neg_hi:[0,1,0]
  v_pk_fma_f32 v[150:151], v[14:15], v[22:23], v[150:151] op_sel_hi:[1,0,1] neg_lo:[0,1,0] neg_hi:[0,1,0]
  v_pk_mul_f32 v[144:145], v[144:145], v[148:149]
  v_pk_mul_f32 v[146:147], v[146:147], v[150:151]
  v_pk_mul_f32 v[144:145], v[144:145], v[22:23] op_sel:[0,1] op_sel_hi:[1,1]
  v_pk_mul_f32 v[146:147], v[146:147], v[22:23] op_sel:[0,1] op_sel_hi:[1,1]
  v_cvt_pk_bf16_f32 v144, v144, v145
  v_cvt_pk_bf16_f32 v145, v146, v147
  ds_write_b64 v28, v[144:145]
  s_waitcnt lgkmcnt(0)
  s_barrier
  s_mul_i32 s85, s32, 27
  s_add_u32 s85, s85, s33
  s_lshl_b32 s85, s85, 7
  s_add_u32 s85, s85, 0x18000
  s_waitcnt vmcnt(0)
  s_barrier
  s_cmp_eq_u32 s36, 0
  s_cbranch_scc0 Lpub_35
  s_cmp_eq_u32 s85, -1
  s_cbranch_scc1 Lpub_35
  v_mov_b32 v140, s78
  v_mov_b32 v141, s79
  v_mov_b32 v142, s85
  s_mov_b64 exec, 1
  buffer_store_dwordx2 v[140:141], v142, s[88:91], 0 offen sc1
  s_mov_b64 exec, -1
Lpub_35:
Linv_26:
  s_and_b32 s39, s2, 7
  s_lshr_b32 s40, s2, 3
  s_lshl_b32 s39, s39, 5
  s_add_u32 s39, s39, s40
  s_cmp_lt_u32 s39, 250
  s_cselect_b32 s87, 1, 0
  s_mul_i32 s40, s39, 525
  s_lshr_b32 s40, s40, 16
  s_mul_i32 s41, s40, 125
  s_sub_u32 s41, s39, s41
  s_mul_i32 s32, s41, 13108
  s_lshr_b32 s32, s32, 16
  s_mul_i32 s33, s32, 5
  s_sub_u32 s33, s41, s33
  s_mul_i32 s40, s40, 5
  s_add_u32 s33, s33, s40
  s_cmp_eq_u32 s87, 0
  s_cbranch_scc1 Linv_37
  s_mul_i32 s34, s32, 82
  s_mul_i32 s35, s33, 64
  s_add_u32 s68, s34, 82
  s_min_u32 s68, s68, 2048
  v_and_b32 v3, 15, v2
  v_lshrrev_b32 v4, 4, v2
  s_lshr_b32 s66, s36, 1
  s_and_b32 s67, s36, 1
  s_mul_i32 s40, s66, 48
  v_lshrrev_b32 v5, 1, v3
  v_xor_b32 v5, v4, v5
  v_lshlrev_b32 v5, 4, v5
  v_lshl_add_u32 v8, v3, 7, v5
  s_lshl_b32 s39, s40, 7
  v_add_u32 v8, s39, v8
  v_lshrrev_b32 v5, 2, v3
  v_lshl_add_u32 v6, v4, 3, v5
  v_lshlrev_b32 v6, 7, v6
  v_lshrrev_b32 v5, 1, v5
  v_and_b32 v7, 1, v4
  v_lshl_or_b32 v5, v7, 1, v5
  v_lshl_add_u32 v6, v5, 5, v6
  v_and_b32 v5, 3, v3
  v_lshl_add_u32 v9, v5, 3, v6
  s_lshl_b32 s39, s67, 6
  v_xor_b32 v9, s39, v9
  v_lshrrev_b32 v5, 1, v4
  v_and_b32 v6, 7, v3
  v_xor_b32 v5, v5, v6
  v_lshlrev_b32 v5, 4, v5
  v_and_b32 v6, 1, v4
  v_lshl_add_u32 v5, v6, 3, v5
  v_lshl_add_u32 v17, v3, 7, v5
  v_add_u32 v17, 0, v17
  s_mul_i32 s39, s66, 6144
  v_add_u32 v17, s39, v17
  s_lshl_b32 s39, s67, 6
  v_xor_b32 v17, s39, v17
  v_xor_b32 v18, 32, v17
  v_mov_b32 v32, 0
  v_mov_b32 v33, 0
  v_mov_b32 v34, 0
  v_mov_b32 v35, 0
  v_mov_b32 v36, 0
  v_mov_b32 v37, 0
  v_mov_b32 v38, 0
  v_mov_b32 v39, 0
  v_mov_b32 v40, 0
  v_mov_b32 v41, 0
  v_mov_b32 v42, 0
  v_mov_b32 v43, 0
  v_mov_b32 v44, 0
  v_mov_b32 v45, 0
  v_mov_b32 v46, 0
  v_mov_b32 v47, 0
  v_mov_b32 v48, 0
  v_mov_b32 v49, 0
  v_mov_b32 v50, 0
  v_mov_b32 v51, 0
  v_mov_b32 v52, 0
  v_mov_b32 v53, 0
  v_mov_b32 v54, 0
  v_mov_b32 v55, 0
  s_mov_b32 s37, 0
  s_mov_b32 s93, 61440
  v_add_u32 v10, s37, v8
  v_add_u32 v12, s93, v9
  v_xor_b32 v11, 64, v10
  v_xor_b32 v13, 32, v12
  s_mov_b32 s20, s58
  s_mov_b32 s21, s59
  s_and_b32 s21, s21, 0xffff
  s_mov_b32 s22, 0x280000
  s_mov_b32 s23, 0x20000
  s_add_u32 s24, s62, 0xb00000
  s_addc_u32 s25, s63, 0
  s_and_b32 s25, s25, 0xffff
  s_mov_b32 s26, 0x280000
  s_mov_b32 s27, 0x20000
  s_mul_i32 s69, s33, 2
  s_mul_i32 s39, s32, 17
  s_add_u32 s69, s69, s39
  s_lshr_b32 s69, s69, 2
  s_mul_i32 s39, s69, 2428
  s_lshr_b32 s39, s39, 16
  s_mul_i32 s39, s39, 27
  s_sub_u32 s69, s69, s39
  s_add_u32 s92, s69, 1
  s_cmp_ge_u32 s92, 27
  s_cselect_b32 s92, 0, s92
  s_mul_i32 s39, s34, 575
  s_lshr_b32 s39, s39, 17
  s_sub_u32 s40, s68, 1
  s_mul_i32 s40, s40, 575
  s_lshr_b32 s40, s40, 17
  s_cmp_eq_u32 s36, 0
  s_cbranch_scc0 Lpollskip_38
  v_lshrrev_b32 v140, 1, v2
  v_add_u32 v140, s39, v140
  v_cmp_ge_u32 vcc, s40, v140
  v_mul_u32_u24 v140, 27, v140
  v_and_b32 v141, 1, v2
  s_sub_u32 s41, s92, s69
  v_mul_lo_u32 v141, v141, s41
  v_add_u32 v141, s69, v141
  v_add_u32 v140, v140, v141
  v_lshlrev_b32 v140, 7, v140
  v_add_u32 v140, 98304, v140
  s_and_saveexec_b64 s[80:81], vcc
  s_mov_b32 s38, 0x40000
Lpoll_39:
  buffer_load_dwordx2 v[142:143], v140, s[88:91], 0 offen sc1
  s_waitcnt vmcnt(0)
  v_cmp_ne_u64 vcc, s[78:79], v[142:143]
  s_cbranch_vccz Lpolldone_40
  s_sub_u32 s38, s38, 1
  s_cmp_lg_u32 s38, 0
  s_cbranch_scc1 Lpoll_39
Lpolldone_40:
  s_mov_b64 exec, s[80:81]
Lpollskip_38:
  s_barrier
  v_lshrrev_b32 v112, 3, v2
  v_and_b32 v113, 7, v2
  v_xor_b32 v108, v113, v112
  v_lshlrev_b32 v108, 4, v108
  v_lshl_add_u32 v108, v112, 7, v108
  s_lshl_b32 s39, s36, 10
  s_add_u32 s39, s39, 0
  v_add_u32 v108, s39, v108
  s_lshl_b32 s39, s36, 3
  s_add_u32 s39, s39, s34
  v_add_u32 v111, s39, v112
  v_mul_u32_u24 v109, 1280, v111
  s_lshl_b32 s39, s35, 1
  v_lshl_add_u32 v109, v113, 4, v109
  v_add_u32 v109, s39, v109
  v_add_u32 v110, 81920, v109
  v_mov_b32 v114, 0x80000000
  v_cmp_gt_u32 vcc, s68, v111
  v_add_u32 v115, 64, v111
  s_nop 0
  v_cndmask_b32 v109, v114, v109, vcc
  v_cmp_gt_u32 vcc, s68, v115
  s_nop 1
  v_cndmask_b32 v110, v114, v110, vcc
  buffer_load_dwordx4 v[100:103], v109, s[24:27], 0 offen sc1
  buffer_load_dwordx4 v[104:107], v110, s[24:27], 0 offen sc1
  s_mul_i32 s39, s34, 575
  s_lshr_b32 s39, s39, 17
  s_sub_u32 s40, s68, 1
  s_mul_i32 s40, s40, 575
  s_lshr_b32 s40, s40, 17
  s_mul_i32 s39, s39, 27
  s_add_u32 s40, s40, 1
  s_mul_i32 s40, s40, 27
  s_cmp_eq_u32 s36, 0
  s_cbranch_scc0 Lpollskip_41
  v_add_u32 v140, s39, v2
  v_cmp_gt_u32 vcc, s40, v140
  v_lshlrev_b32 v140, 7, v140
  v_add_u32 v140, 98304, v140
  s_and_saveexec_b64 s[80:81], vcc
  s_mov_b32 s38, 0x40000
Lpoll_42:
  buffer_load_dwordx2 v[142:143], v140, s[88:91], 0 offen sc1
  s_waitcnt vmcnt(0)
  v_cmp_ne_u64 vcc, s[78:79], v[142:143]
  s_cbranch_vccz Lpolldone_43
  s_sub_u32 s38, s38, 1
  s_cmp_lg_u32 s38, 0
  s_cbranch_scc1 Lpoll_42
Lpolldone_43:
  s_mov_b64 exec, s[80:81]
Lpollskip_41:
  s_barrier
  ds_read_b64_tr_b16 a[0:1], v12 offset:0
  ds_read_b64_tr_b16 a[2:3], v12 offset:512
  ds_read_b64_tr_b16 a[4:5], v13 offset:0
  ds_read_b64_tr_b16 a[6:7], v13 offset:512
  ds_read_b128 a[16:19], v10 offset:0
  ds_read_b128 a[20:23], v10 offset:2048
  ds_read_b128 a[24:27], v10 offset:4096
  ds_read_b64_tr_b16 a[8:9], v12 offset:4096
  ds_read_b64_tr_b16 a[10:11], v12 offset:4608
  ds_read_b64_tr_b16 a[12:13], v13 offset:4096
  ds_read_b64_tr_b16 a[14:15], v13 offset:4608
  ds_read_b128 a[28:31], v11 offset:0
  ds_read_b128 a[32:35], v11 offset:2048
  ds_read_b128 a[36:39], v11 offset:4096
  s_add_u32 s37, s37, 12288
  s_cmp_ge_u32 s37, 61440
  s_cselect_b32 s37, 0, s37
  s_add_u32 s93, s93, 8192
  s_cmp_ge_u32 s93, 159744
  s_cselect_b32 s93, 61440, s93
  v_add_u32 v10, s37, v8
  v_add_u32 v12, s93, v9
  v_xor_b32 v11, 64, v10
  v_xor_b32 v13, 32, v12
  s_mov_b32 s38, 13
.p2align 6
Lcloop_44:
  s_waitcnt lgkmcnt(0)
  s_barrier
  v_mfma_f32_16x16x32_bf16 v[32:35], a[0:3], a[16:19], v[32:35]
  ds_read_b64_tr_b16 a[40:41], v12 offset:0
  ds_read_b64_tr_b16 a[42:43], v12 offset:512
  v_mfma_f32_16x16x32_bf16 v[36:39], a[4:7], a[16:19], v[36:39]
  ds_read_b64_tr_b16 a[44:45], v13 offset:0
  ds_read_b64_tr_b16 a[46:47], v13 offset:512
  v_mfma_f32_16x16x32_bf16 v[40:43], a[0:3], a[20:23], v[40:43]
  ds_read_b128 a[56:59], v10 offset:0
  ds_read_b128 a[60:63], v10 offset:2048
  v_mfma_f32_16x16x32_bf16 v[44:47], a[4:7], a[20:23], v[44:47]
  ds_read_b128 a[64:67], v10 offset:4096
  ds_read_b64_tr_b16 a[48:49], v12 offset:4096
  v_mfma_f32_16x16x32_bf16 v[48:51], a[0:3], a[24:27], v[48:51]
  ds_read_b64_tr_b16 a[50:51], v12 offset:4608
  ds_read_b64_tr_b16 a[52:53], v13 offset:4096
  v_mfma_f32_16x16x32_bf16 v[52:55], a[4:7], a[24:27], v[52:55]
  ds_read_b64_tr_b16 a[54:55], v13 offset:4608
  ds_read_b128 a[68:71], v11 offset:0
  v_mfma_f32_16x16x32_bf16 v[32:35], a[8:11], a[28:31], v[32:35]
  ds_read_b128 a[72:75], v11 offset:2048
  ds_read_b128 a[76:79], v11 offset:4096
  v_mfma_f32_16x16x32_bf16 v[36:39], a[12:15], a[28:31], v[36:39]
  s_add_u32 s37, s37, 12288
  s_cmp_ge_u32 s37, 61440
  v_mfma_f32_16x16x32_bf16 v[40:43], a[8:11], a[32:35], v[40:43]
  s_cselect_b32 s37, 0, s37
  s_add_u32 s93, s93, 8192
  v_mfma_f32_16x16x32_bf16 v[44:47], a[12:15], a[32:35], v[44:47]
  s_cmp_ge_u32 s93, 159744
  s_cselect_b32 s93, 61440, s93
  v_mfma_f32_16x16x32_bf16 v[48:51], a[8:11], a[36:39], v[48:51]
  v_add_u32 v10, s37, v8
  v_add_u32 v12, s93, v9
  v_mfma_f32_16x16x32_bf16 v[52:55], a[12:15], a[36:39], v[52:55]
  v_xor_b32 v11, 64, v10
  v_xor_b32 v13, 32, v12
  s_sub_u32 s38, s38, 1
  s_waitcnt lgkmcnt(0)
  s_barrier
  v_mfma_f32_16x16x32_bf16 v[32:35], a[40:43], a[56:59], v[32:35]
  ds_read_b64_tr_b16 a[0:1], v12 offset:0
  ds_read_b64_tr_b16 a[2:3], v12 offset:512
  v_mfma_f32_16x16x32_bf16 v[36:39], a[44:47], a[56:59], v[36:39]
  ds_read_b64_tr_b16 a[4:5], v13 offset:0
  ds_read_b64_tr_b16 a[6:7], v13 offset:512
  v_mfma_f32_16x16x32_bf16 v[40:43], a[40:43], a[60:63], v[40:43]
  ds_read_b128 a[16:19], v10 offset:0
  ds_read_b128 a[20:23], v10 offset:2048
  v_mfma_f32_16x16x32_bf16 v[44:47], a[44:47], a[60:63], v[44:47]
  ds_read_b128 a[24:27], v10 offset:4096
  ds_read_b64_tr_b16 a[8:9], v12 offset:4096
  v_mfma_f32_16x16x32_bf16 v[48:51], a[40:43], a[64:67], v[48:51]
  ds_read_b64_tr_b16 a[10:11], v12 offset:4608
  ds_read_b64_tr_b16 a[12:13], v13 offset:4096
  v_mfma_f32_16x16x32_bf16 v[52:55], a[44:47], a[64:67], v[52:55]
  ds_read_b64_tr_b16 a[14:15], v13 offset:4608
  ds_read_b128 a[28:31], v11 offset:0
  v_mfma_f32_16x16x32_bf16 v[32:35], a[48:51], a[68:71], v[32:35]
  ds_read_b128 a[32:35], v11 offset:2048
  ds_read_b128 a[36:39], v11 offset:4096
  v_mfma_f32_16x16x32_bf16 v[36:39], a[52:55], a[68:71], v[36:39]
  s_add_u32 s37, s37, 12288
  s_cmp_ge_u32 s37, 61440
  v_mfma_f32_16x16x32_bf16 v[40:43], a[48:51], a[72:75], v[40:43]
  s_cselect_b32 s37, 0, s37
  s_add_u32 s93, s93, 8192
  v_mfma_f32_16x16x32_bf16 v[44:47], a[52:55], a[72:75], v[44:47]
  s_cmp_ge_u32 s93, 159744
  s_cselect_b32 s93, 61440, s93
  v_mfma_f32_16x16x32_bf16 v[48:51], a[48:51], a[76:79], v[48:51]
  v_add_u32 v10, s37, v8
  v_add_u32 v12, s93, v9
  v_mfma_f32_16x16x32_bf16 v[52:55], a[52:55], a[76:79], v[52:55]
  v_xor_b32 v11, 64, v10
  v_xor_b32 v13, 32, v12
  s_cmp_lg_u32 s38, 0
  s_cbranch_scc1 Lcloop_44
  s_waitcnt lgkmcnt(0)
  v_mfma_f32_16x16x32_bf16 v[32:35], a[0:3], a[16:19], v[32:35]
  v_mfma_f32_16x16x32_bf16 v[36:39], a[4:7], a[16:19], v[36:39]
  v_mfma_f32_16x16x32_bf16 v[40:43], a[0:3], a[20:23], v[40:43]
  v_mfma_f32_16x16x32_bf16 v[44:47], a[4:7], a[20:23], v[44:47]
  v_mfma_f32_16x16x32_bf16 v[48:51], a[0:3], a[24:27], v[48:51]
  v_mfma_f32_16x16x32_bf16 v[52:55], a[4:7], a[24:27], v[52:55]
  v_mfma_f32_16x16x32_bf16 v[32:35], a[8:11], a[28:31], v[32:35]
  v_mfma_f32_16x16x32_bf16 v[36:39], a[12:15], a[28:31], v[36:39]
  v_mfma_f32_16x16x32_bf16 v[40:43], a[8:11], a[32:35], v[40:43]
  v_mfma_f32_16x16x32_bf16 v[44:47], a[12:15], a[32:35], v[44:47]
  v_mfma_f32_16x16x32_bf16 v[48:51], a[8:11], a[36:39], v[48:51]
  v_mfma_f32_16x16x32_bf16 v[52:55], a[12:15], a[36:39], v[52:55]
  s_nop 7
  v_cvt_pk_bf16_f32 v32, v32, v33
  v_cvt_pk_bf16_f32 v33, v34, v35
  ds_write_b64 v17, v[32:33] offset:0
  v_cvt_pk_bf16_f32 v36, v36, v37
  v_cvt_pk_bf16_f32 v37, v38, v39
  ds_write_b64 v18, v[36:37] offset:0
  v_cvt_pk_bf16_f32 v40, v40, v41
  v_cvt_pk_bf16_f32 v41, v42, v43
  ds_write_b64 v17, v[40:41] offset:2048
  v_cvt_pk_bf16_f32 v44, v44, v45
  v_cvt_pk_bf16_f32 v45, v46, v47
  ds_write_b64 v18, v[44:45] offset:2048
  v_cvt_pk_bf16_f32 v48, v48, v49
  v_cvt_pk_bf16_f32 v49, v50, v51
  ds_write_b64 v17, v[48:49] offset:4096
  v_cvt_pk_bf16_f32 v52, v52, v53
  v_cvt_pk_bf16_f32 v53, v54, v55
  ds_write_b64 v18, v[52:53] offset:4096
  s_waitcnt lgkmcnt(0)
  s_barrier
  ds_read_b128 v[16:19], v108 offset:0
  ds_read_b128 v[20:23], v108 offset:8192
  s_waitcnt vmcnt(0) lgkmcnt(0)
  v_lshlrev_b32 v28, 16, v16
  v_and_b32 v29, 0xffff0000, v16
  v_lshlrev_b32 v30, 16, v100
  v_and_b32 v31, 0xffff0000, v100
  v_pk_add_f32 v[28:29], v[28:29], v[30:31]
  v_cvt_pk_bf16_f32 v16, v28, v29
  v_lshlrev_b32 v28, 16, v17
  v_and_b32 v29, 0xffff0000, v17
  v_lshlrev_b32 v30, 16, v101
  v_and_b32 v31, 0xffff0000, v101
  v_pk_add_f32 v[28:29], v[28:29], v[30:31]
  v_cvt_pk_bf16_f32 v17, v28, v29
  v_lshlrev_b32 v28, 16, v18
  v_and_b32 v29, 0xffff0000, v18
  v_lshlrev_b32 v30, 16, v102
  v_and_b32 v31, 0xffff0000, v102
  v_pk_add_f32 v[28:29], v[28:29], v[30:31]
  v_cvt_pk_bf16_f32 v18, v28, v29
  v_lshlrev_b32 v28, 16, v19
  v_and_b32 v29, 0xffff0000, v19
  v_lshlrev_b32 v30, 16, v103
  v_and_b32 v31, 0xffff0000, v103
  v_pk_add_f32 v[28:29], v[28:29], v[30:31]
  v_cvt_pk_bf16_f32 v19, v28, v29
  buffer_store_dwordx4 v[16:19], v109, s[20:23], 0 offen sc0 sc1
  s_cmp_ge_u32 s36, 3
  s_cbranch_scc1 Lsdone_45
  v_lshlrev_b32 v28, 16, v20
  v_and_b32 v29, 0xffff0000, v20
  v_lshlrev_b32 v30, 16, v104
  v_and_b32 v31, 0xffff0000, v104
  v_pk_add_f32 v[28:29], v[28:29], v[30:31]
  v_cvt_pk_bf16_f32 v20, v28, v29
  v_lshlrev_b32 v28, 16, v21
  v_and_b32 v29, 0xffff0000, v21
  v_lshlrev_b32 v30, 16, v105
  v_and_b32 v31, 0xffff0000, v105
  v_pk_add_f32 v[28:29], v[28:29], v[30:31]
  v_cvt_pk_bf16_f32 v21, v28, v29
  v_lshlrev_b32 v28, 16, v22
  v_and_b32 v29, 0xffff0000, v22
  v_lshlrev_b32 v30, 16, v106
  v_and_b32 v31, 0xffff0000, v106
  v_pk_add_f32 v[28:29], v[28:29], v[30:31]
  v_cvt_pk_bf16_f32 v22, v28, v29
  v_lshlrev_b32 v28, 16, v23
  v_and_b32 v29, 0xffff0000, v23
  v_lshlrev_b32 v30, 16, v107
  v_and_b32 v31, 0xffff0000, v107
  v_pk_add_f32 v[28:29], v[28:29], v[30:31]
  v_cvt_pk_bf16_f32 v23, v28, v29
  buffer_store_dwordx4 v[20:23], v110, s[20:23], 0 offen sc0 sc1
Lsdone_45:
  s_mov_b32 s85, -1
Linv_37:
  s_waitcnt vmcnt(0)
  s_endpgm
L_loader:
  s_and_b32 s39, s2, 7
  s_lshr_b32 s40, s2, 3
  s_lshl_b32 s39, s39, 5
  s_add_u32 s39, s39, s40
  s_cmp_lt_u32 s39, 256
  s_cselect_b32 s87, 1, 0
  s_lshr_b32 s40, s39, 6
  s_lshl_b32 s32, s40, 3
  s_bfe_u32 s41, s39, 196610
  s_add_u32 s32, s32, s41
  s_bfe_u32 s40, s39, 65541
  s_lshl_b32 s40, s40, 2
  s_and_b32 s33, s39, 3
  s_add_u32 s33, s33, s40
  s_cmp_eq_u32 s87, 0
  s_cbranch_scc1 Linv_47
  s_lshl_b32 s34, s32, 6
  s_sub_u32 s34, s34, 14
  s_mul_i32 s35, s33, 160
  v_lshrrev_b32 v3, 3, v2
  v_and_b32 v4, 7, v2
  v_lshrrev_b32 v5, 1, v3
  v_xor_b32 v6, v4, v5
  v_lshlrev_b32 v6, 4, v6
  s_lshl_b32 s39, s96, 3
  s_add_u32 s39, s39, s34
  v_add_u32 v7, s39, v3
  s_mov_b32 s39, 1280
  v_mul_lo_u32 v7, v7, s39
  v_add_u32 v7, v7, v6
  s_and_b32 s39, s96, 1
  s_lshl_b32 s39, s39, 6
  v_xor_b32 v7, s39, v7
  v_add_u32 v32, 0, v7
  v_add_u32 v33, 40960, v7
  v_add_u32 v34, 81920, v7
  s_lshl_b32 s86, s96, 10
  s_cmp_eq_u32 s96, 0
  s_cselect_b32 s65, -1, 0xffff
  s_cmp_lt_u32 s96, 2
  s_cselect_b32 s64, -1, 0
  s_cselect_b32 s65, s65, 0
  s_add_u32 s69, s32, s33
  s_mul_i32 s39, s69, 13108
  s_lshr_b32 s39, s39, 16
  s_mul_i32 s39, s39, 5
  s_sub_u32 s69, s69, s39
  s_lshl_b32 s69, s69, 1
  s_mov_b32 s92, s69
  s_mov_b32 s6, 0
  s_mov_b32 s7, 0
  s_waitcnt lgkmcnt(0)
  s_add_u32 s88, s62, 0x1900000
  s_addc_u32 s89, s63, 0
  s_and_b32 s89, s89, 0xffff
  s_mov_b32 s90, 0x20000
  s_mov_b32 s91, 0x20000
  s_mov_b32 s8, s44
  s_mov_b32 s9, s45
  s_and_b32 s9, s9, 0xffff
  s_mov_b32 s10, 0x280000
  s_mov_b32 s11, 0x20000
  s_mov_b32 s12, s46
  s_mov_b32 s13, s47
  s_and_b32 s13, s13, 0xffff
  s_mov_b32 s14, 0x258000
  s_mov_b32 s15, 0x20000
  s_add_u32 s20, s62, 0x800000
  s_addc_u32 s21, s63, 0
  s_and_b32 s21, s21, 0xffff
  s_mov_b32 s22, 0x280000
  s_mov_b32 s23, 0x20000
  s_mov_b32 s37, 0
  s_mov_b32 s93, 0
  s_mul_i32 s42, s69, 128
  s_mul_i32 s43, s92, 245760
  s_add_u32 s94, s37, s86
  s_add_u32 m0, s94, 0
  s_nop 0
  buffer_load_dwordx4 v32, s[8:11], s42 offen lds
  s_add_u32 m0, s94, 4096
  s_nop 0
  buffer_load_dwordx4 v33, s[8:11], s42 offen lds
  s_cmp_eq_u64 s[64:65], 0
  s_cbranch_scc1 Lsk_48
  s_add_u32 m0, s94, 8192
  s_mov_b64 exec, s[64:65]
  buffer_load_dwordx4 v34, s[8:11], s42 offen lds
  s_mov_b64 exec, -1
Lsk_48:
  s_add_u32 s69, s69, 2
  s_cmp_ge_u32 s69, 10
  s_cselect_b32 s39, 10, 0
  s_sub_u32 s69, s69, s39
  s_add_u32 s6, s6, 1
  s_cmp_eq_u32 s6, 5
  s_addc_u32 s69, s69, 0
  s_mul_i32 s42, s69, 128
  s_add_u32 s37, s37, 40960
  s_cmp_ge_u32 s37, 122880
  s_cselect_b32 s37, 0, s37
  s_lshl_b32 s39, s96, 6
  v_add_u32 v8, s39, v2
  v_mul_u32_u24 v9, 205, v8
  v_lshrrev_b32 v9, 11, v9
  v_mul_u32_u24 v10, 10, v9
  v_sub_u32 v10, v8, v10
  v_mul_u32_u24 v11, 3840, v9
  v_lshl_add_u32 v11, v10, 4, v11
  v_add_u32 v35, s35, v11
  v_add_u32 v10, 6, v10
  v_add_u32 v9, 25, v9
  v_cmp_le_u32 vcc, 10, v10
  v_add_u32 v36, 96096, v35
  v_subrev_u32 v12, 10, v10
  v_cndmask_b32 v10, v10, v12, vcc
  v_add_u32 v12, 3680, v36
  v_cndmask_b32 v36, v36, v12, vcc
  v_add_u32 v12, 1, v9
  v_cndmask_b32 v9, v9, v12, vcc
  v_cmp_le_u32 vcc, 64, v9
  v_add_u32 v12, 4294722816, v36
  v_subrev_u32 v13, 64, v9
  v_cndmask_b32 v36, v36, v12, vcc
  v_cndmask_b32 v9, v9, v13, vcc
  v_add_u32 v10, 6, v10
  v_add_u32 v9, 25, v9
  v_cmp_le_u32 vcc, 10, v10
  v_add_u32 v37, 96096, v36
  v_subrev_u32 v12, 10, v10
  v_cndmask_b32 v10, v10, v12, vcc
  v_add_u32 v12, 3680, v37
  v_cndmask_b32 v37, v37, v12, vcc
  v_add_u32 v12, 1, v9
  v_cndmask_b32 v9, v9, v12, vcc
  v_cmp_le_u32 vcc, 64, v9
  v_add_u32 v12, 4294722816, v37
  v_subrev_u32 v13, 64, v9
  v_cndmask_b32 v37, v37, v12, vcc
  v_cndmask_b32 v9, v9, v13, vcc
  v_add_u32 v10, 6, v10
  v_add_u32 v9, 25, v9
  v_cmp_le_u32 vcc, 10, v10
  v_add_u32 v38, 96096, v37
  v_subrev_u32 v12, 10, v10
  v_cndmask_b32 v10, v10, v12, vcc
  v_add_u32 v12, 3680, v38
  v_cndmask_b32 v38, v38, v12, vcc
  v_add_u32 v12, 1, v9
  v_cndmask_b32 v9, v9, v12, vcc
  v_cmp_le_u32 vcc, 64, v9
  v_add_u32 v12, 4294722816, v38
  v_subrev_u32 v13, 64, v9
  v_cndmask_b32 v38, v38, v12, vcc
  v_cndmask_b32 v9, v9, v13, vcc
  v_add_u32 v10, 6, v10
  v_add_u32 v9, 25, v9
  v_cmp_le_u32 vcc, 10, v10
  v_add_u32 v39, 96096, v38
  v_subrev_u32 v12, 10, v10
  v_cndmask_b32 v10, v10, v12, vcc
  v_add_u32 v12, 3680, v39
  v_cndmask_b32 v39, v39, v12, vcc
  v_add_u32 v12, 1, v9
  v_cndmask_b32 v9, v9, v12, vcc
  v_cmp_le_u32 vcc, 64, v9
  v_add_u32 v12, 4294722816, v39
  v_subrev_u32 v13, 64, v9
  v_cndmask_b32 v39, v39, v12, vcc
  v_cndmask_b32 v9, v9, v13, vcc
  v_add_u32 v10, 6, v10
  v_add_u32 v9, 25, v9
  v_cmp_le_u32 vcc, 10, v10
  v_add_u32 v40, 96096, v39
  v_subrev_u32 v12, 10, v10
  v_cndmask_b32 v10, v10, v12, vcc
  v_add_u32 v12, 3680, v40
  v_cndmask_b32 v40, v40, v12, vcc
  v_add_u32 v12, 1, v9
  v_cndmask_b32 v9, v9, v12, vcc
  v_cmp_le_u32 vcc, 64, v9
  v_add_u32 v12, 4294722816, v40
  v_subrev_u32 v13, 64, v9
  v_cndmask_b32 v40, v40, v12, vcc
  v_cndmask_b32 v9, v9, v13, vcc
  v_add_u32 v10, 6, v10
  v_add_u32 v9, 25, v9
  v_cmp_le_u32 vcc, 10, v10
  v_add_u32 v41, 96096, v40
  v_subrev_u32 v12, 10, v10
  v_cndmask_b32 v10, v10, v12, vcc
  v_add_u32 v12, 3680, v41
  v_cndmask_b32 v41, v41, v12, vcc
  v_add_u32 v12, 1, v9
  v_cndmask_b32 v9, v9, v12, vcc
  v_cmp_le_u32 vcc, 64, v9
  v_add_u32 v12, 4294722816, v41
  v_subrev_u32 v13, 64, v9
  v_cndmask_b32 v41, v41, v12, vcc
  v_cndmask_b32 v9, v9, v13, vcc
  v_add_u32 v10, 6, v10
  v_add_u32 v9, 25, v9
  v_cmp_le_u32 vcc, 10, v10
  v_add_u32 v42, 96096, v41
  v_subrev_u32 v12, 10, v10
  v_cndmask_b32 v10, v10, v12, vcc
  v_add_u32 v12, 3680, v42
  v_cndmask_b32 v42, v42, v12, vcc
  v_add_u32 v12, 1, v9
  v_cndmask_b32 v9, v9, v12, vcc
  v_cmp_le_u32 vcc, 64, v9
  v_add_u32 v12, 4294722816, v42
  v_subrev_u32 v13, 64, v9
  v_cndmask_b32 v42, v42, v12, vcc
  v_cndmask_b32 v9, v9, v13, vcc
  s_add_u32 s95, s93, s86
  s_add_u32 m0, s95, 10240
  s_nop 0
  buffer_load_dwordx4 v35, s[12:15], s43 offen lds
  s_add_u32 m0, s95, 14336
  s_nop 0
  buffer_load_dwordx4 v36, s[12:15], s43 offen lds
  s_add_u32 m0, s95, 18432
  s_nop 0
  buffer_load_dwordx4 v37, s[12:15], s43 offen lds
  s_add_u32 m0, s95, 22528
  s_nop 0
  buffer_load_dwordx4 v38, s[12:15], s43 offen lds
  s_add_u32 m0, s95, 26624
  s_nop 0
  buffer_load_dwordx4 v39, s[12:15], s43 offen lds
  s_add_u32 m0, s95, 30720
  s_nop 0
  buffer_load_dwordx4 v40, s[12:15], s43 offen lds
  s_add_u32 m0, s95, 34816
  s_nop 0
  buffer_load_dwordx4 v41, s[12:15], s43 offen lds
  s_cmp_ge_u32 s96, 2
  s_cbranch_scc1 Lskb_49
  s_add_u32 m0, s95, 38912
  s_nop 0
  buffer_load_dwordx4 v42, s[12:15], s43 offen lds
Lskb_49:
  s_add_u32 s92, s92, 2
  s_cmp_ge_u32 s92, 10
  s_cselect_b32 s39, 10, 0
  s_sub_u32 s92, s92, s39
  s_add_u32 s7, s7, 1
  s_cmp_eq_u32 s7, 5
  s_addc_u32 s92, s92, 0
  s_mul_i32 s43, s92, 245760
  s_add_u32 s93, s93, 40960
  s_cmp_ge_u32 s93, 122880
  s_cselect_b32 s93, 0, s93
  s_add_u32 s94, s37, s86
  s_add_u32 m0, s94, 0
  s_nop 0
  buffer_load_dwordx4 v32, s[8:11], s42 offen lds
  s_add_u32 m0, s94, 4096
  s_nop 0
  buffer_load_dwordx4 v33, s[8:11], s42 offen lds
  s_cmp_eq_u64 s[64:65], 0
  s_cbranch_scc1 Lsk_50
  s_add_u32 m0, s94, 8192
  s_mov_b64 exec, s[64:65]
  buffer_load_dwordx4 v34, s[8:11], s42 offen lds
  s_mov_b64 exec, -1
Lsk_50:
  s_add_u32 s69, s69, 2
  s_cmp_ge_u32 s69, 10
  s_cselect_b32 s39, 10, 0
  s_sub_u32 s69, s69, s39
  s_add_u32 s6, s6, 1
  s_cmp_eq_u32 s6, 5
  s_addc_u32 s69, s69, 0
  s_mul_i32 s42, s69, 128
  s_add_u32 s37, s37, 40960
  s_cmp_ge_u32 s37, 122880
  s_cselect_b32 s37, 0, s37
  s_add_u32 s95, s93, s86
  s_add_u32 m0, s95, 10240
  s_nop 0
  buffer_load_dwordx4 v35, s[12:15], s43 offen lds
  s_add_u32 m0, s95, 14336
  s_nop 0
  buffer_load_dwordx4 v36, s[12:15], s43 offen lds
  s_add_u32 m0, s95, 18432
  s_nop 0
  buffer_load_dwordx4 v37, s[12:15], s43 offen lds
  s_add_u32 m0, s95, 22528
  s_nop 0
  buffer_load_dwordx4 v38, s[12:15], s43 offen lds
  s_add_u32 m0, s95, 26624
  s_nop 0
  buffer_load_dwordx4 v39, s[12:15], s43 offen lds
  s_add_u32 m0, s95, 30720
  s_nop 0
  buffer_load_dwordx4 v40, s[12:15], s43 offen lds
  s_add_u32 m0, s95, 34816
  s_nop 0
  buffer_load_dwordx4 v41, s[12:15], s43 offen lds
  s_cmp_ge_u32 s96, 2
  s_cbranch_scc1 Lskb_51
  s_add_u32 m0, s95, 38912
  s_nop 0
  buffer_load_dwordx4 v42, s[12:15], s43 offen lds
Lskb_51:
  s_add_u32 s92, s92, 2
  s_cmp_ge_u32 s92, 10
  s_cselect_b32 s39, 10, 0
  s_sub_u32 s92, s92, s39
  s_add_u32 s7, s7, 1
  s_cmp_eq_u32 s7, 5
  s_addc_u32 s92, s92, 0
  s_mul_i32 s43, s92, 245760
  s_add_u32 s93, s93, 40960
  s_cmp_ge_u32 s93, 122880
  s_cselect_b32 s93, 0, s93
  v_mov_b32 v12, 0
  v_mov_b32 v13, 0
  v_mov_b32 v14, 0
  v_mov_b32 v15, 0
  v_mov_b32 v10, 0x3f803f80
  v_lshlrev_b32 v11, 4, v2
  s_add_u32 s39, s96, 0
  s_cmp_ge_u32 s39, 3
  s_cbranch_scc1 Lpad_52
  s_mul_i32 s39, s39, 40960
  v_add_u32 v16, s39, v11
  s_mov_b32 exec_lo, 0xff
  s_mov_b32 exec_hi, 0x0
  ds_write_b128 v16, v[12:15] offset:9984
  s_mov_b64 exec, -1
  v_lshlrev_b32 v16, 2, v2
  v_add_u32 v16, s39, v16
  s_mov_b32 exec_lo, 0xffffffff
  s_mov_b32 exec_hi, 0x0
  ds_write_b32 v16, v10 offset:10112
  s_mov_b64 exec, -1
Lpad_52:
  v_and_b32 v3, 3, v2
  v_bfe_u32 v4, v2, 2, 2
  v_lshrrev_b32 v5, 4, v2
  v_lshrrev_b32 v6, 1, v5
  v_lshlrev_b32 v6, 3, v6
  v_and_b32 v7, 1, v5
  v_add_u32 v6, v6, v7
  s_lshl_b32 s39, s96, 4
  v_add_u32 v6, s39, v6
  v_lshlrev_b32 v7, 1, v3
  v_add_u32 v7, v6, v7
  v_mul_u32_u24 v8, 488, v7
  v_mul_u32_u24 v9, 40, v4
  v_add_u32 v8, v8, v9
  v_add_u32 v144, 47792, v8
  v_add_u32 v145, 41120, v8
  v_cmp_eq_u32 vcc, 3, v3
  v_mov_b32 v10, 7808
  v_mov_b32 v11, 6832
  v_cndmask_b32 v10, v10, v11, vcc
  v_add_u32 v146, v145, v10
  v_mul_u32_u24 v12, 176, v7
  v_add_u32 v12, v12, v9
  v_add_u32 v118, 81920, v12
  v_lshlrev_b32 v12, 1, v4
  v_add_u32 v12, v6, v12
  v_mul_u32_u24 v12, 488, v12
  v_mul_u32_u24 v13, 40, v3
  v_add_u32 v12, v12, v13
  v_add_u32 v147, 41280, v12
  v_cmp_eq_u32 vcc, 3, v4
  v_mov_b32 v10, 7808
  s_nop 0
  v_cndmask_b32 v10, v10, v11, vcc
  v_add_u32 v119, v147, v10
  v_mov_b32 v12, 0xf149f2ca
  v_mov_b32 v13, 0
  v_add_u32 v14, s34, v6
  v_sub_u32 v15, 0, v3
  v_cmp_gt_u32 vcc, 8, v15
  v_add_u32 v16, 0, v14
  v_cmp_le_i32 s[4:5], 0, v16
  s_nop 1
  s_and_b64 vcc, vcc, s[4:5]
  v_cndmask_b32 v120, v12, v13, vcc
  v_sub_u32 v15, 1, v3
  v_cmp_gt_u32 vcc, 8, v15
  v_add_u32 v16, 2, v14
  v_cmp_le_i32 s[4:5], 0, v16
  s_nop 1
  s_and_b64 vcc, vcc, s[4:5]
  v_cndmask_b32 v121, v12, v13, vcc
  v_sub_u32 v15, 2, v3
  v_cmp_gt_u32 vcc, 8, v15
  v_add_u32 v16, 4, v14
  v_cmp_le_i32 s[4:5], 0, v16
  s_nop 1
  s_and_b64 vcc, vcc, s[4:5]
  v_cndmask_b32 v122, v12, v13, vcc
  v_sub_u32 v15, 3, v3
  v_cmp_gt_u32 vcc, 8, v15
  v_add_u32 v16, 6, v14
  v_cmp_le_i32 s[4:5], 0, v16
  s_nop 1
  s_and_b64 vcc, vcc, s[4:5]
  v_cndmask_b32 v123, v12, v13, vcc
  v_sub_u32 v15, 4, v3
  v_cmp_gt_u32 vcc, 8, v15
  v_add_u32 v16, 8, v14
  v_cmp_le_i32 s[4:5], 0, v16
  s_nop 1
  s_and_b64 vcc, vcc, s[4:5]
  v_cndmask_b32 v124, v12, v13, vcc
  v_sub_u32 v15, 5, v3
  v_cmp_gt_u32 vcc, 8, v15
  v_add_u32 v16, 10, v14
  v_cmp_le_i32 s[4:5], 0, v16
  s_nop 1
  s_and_b64 vcc, vcc, s[4:5]
  v_cndmask_b32 v125, v12, v13, vcc
  v_sub_u32 v15, 6, v3
  v_cmp_gt_u32 vcc, 8, v15
  v_add_u32 v16, 12, v14
  v_cmp_le_i32 s[4:5], 0, v16
  s_nop 1
  s_and_b64 vcc, vcc, s[4:5]
  v_cndmask_b32 v126, v12, v13, vcc
  v_sub_u32 v15, 7, v3
  v_cmp_gt_u32 vcc, 8, v15
  v_add_u32 v16, 14, v14
  v_cmp_le_i32 s[4:5], 0, v16
  s_nop 1
  s_and_b64 vcc, vcc, s[4:5]
  v_cndmask_b32 v127, v12, v13, vcc
  v_sub_u32 v15, 8, v3
  v_cmp_gt_u32 vcc, 8, v15
  v_add_u32 v16, 16, v14
  v_cmp_le_i32 s[4:5], 0, v16
  s_nop 1
  s_and_b64 vcc, vcc, s[4:5]
  v_cndmask_b32 v128, v12, v13, vcc
  v_sub_u32 v15, 9, v3
  v_cmp_gt_u32 vcc, 8, v15
  v_add_u32 v16, 18, v14
  v_cmp_le_i32 s[4:5], 0, v16
  s_nop 1
  s_and_b64 vcc, vcc, s[4:5]
  v_cndmask_b32 v129, v12, v13, vcc
  v_sub_u32 v15, 10, v3
  v_cmp_gt_u32 vcc, 8, v15
  v_add_u32 v16, 20, v14
  v_cmp_le_i32 s[4:5], 0, v16
  s_nop 1
  s_and_b64 vcc, vcc, s[4:5]
  v_cndmask_b32 v130, v12, v13, vcc
  v_sub_u32 v15, 11, v3
  v_cmp_gt_u32 vcc, 8, v15
  v_add_u32 v16, 22, v14
  v_cmp_le_i32 s[4:5], 0, v16
  s_nop 1
  s_and_b64 vcc, vcc, s[4:5]
  v_cndmask_b32 v131, v12, v13, vcc
  v_lshrrev_b32 v3, 3, v2
  v_and_b32 v4, 7, v2
  s_lshl_b32 s39, s36, 3
  v_add_u32 v5, s39, v3
  v_mul_u32_u24 v148, 176, v5
  v_lshl_add_u32 v148, v4, 4, v148
  v_add_u32 v148, 81920, v148
  s_add_u32 s39, s34, 14
  v_add_u32 v156, s39, v5
  v_lshlrev_b32 v156, 10, v156
  v_lshl_add_u32 v156, v4, 4, v156
  s_lshl_b32 s40, s33, 7
  v_add_u32 v156, s40, v156
  v_lshrrev_b32 v3, 1, v4
  v_lshl_add_u32 v3, v5, 2, v3
  v_mul_u32_u24 v149, 176, v3
  v_and_b32 v3, 1, v4
  v_lshl_add_u32 v149, v3, 4, v149
  v_add_u32 v149, 82048, v149
  s_lshr_b32 s39, s39, 2
  v_add_u32 v157, s39, v5
  v_lshlrev_b32 v157, 10, v157
  v_lshl_add_u32 v157, v4, 4, v157
  s_add_u32 s40, s40, 0x200000
  v_add_u32 v157, s40, v157
  s_mov_b32 s4, s32
  s_mov_b32 s5, s33
  s_and_b32 s39, s2, 7
  s_lshr_b32 s40, s2, 3
  s_lshl_b32 s39, s39, 5
  s_add_u32 s39, s39, s40
  s_cmp_lt_u32 s39, 250
  s_cselect_b32 s87, 1, 0
  s_mul_i32 s32, s39, 6554
  s_lshr_b32 s32, s32, 16
  s_mul_i32 s33, s32, 10
  s_sub_u32 s33, s39, s33
  s_mul_i32 s39, s32, 21846
  s_lshr_b32 s39, s39, 16
  s_mul_i32 s39, s39, 3
  s_sub_u32 s39, s32, s39
  s_mul_i32 s39, s39, 216
  s_lshl_b32 s40, s96, 3
  s_add_u32 s39, s39, s40
  v_lshrrev_b32 v150, 3, v2
  v_add_u32 v150, s39, v150
  s_mov_b32 s40, 1280
  v_mul_lo_u32 v150, v150, s40
  v_and_b32 v151, 7, v2
  v_lshl_add_u32 v150, v151, 4, v150
  s_mul_i32 s40, s33, 128
  v_add_u32 v150, s40, v150
  s_cmp_eq_u32 s87, 0
  s_cselect_b32 s40, 0x80000000, 0
  v_or_b32 v150, s40, v150
  s_mov_b32 s80, s48
  s_mov_b32 s81, s49
  s_and_b32 s81, s81, 0xffff
  s_mov_b32 s82, 0xc8000
  s_mov_b32 s83, 0x20000
  s_mov_b32 s32, s4
  s_mov_b32 s33, s5
  s_waitcnt vmcnt(9)
  s_waitcnt lgkmcnt(0)
  s_barrier
  s_mov_b32 s38, 6
Llmain_53:
  s_add_u32 s94, s37, s86
  s_add_u32 m0, s94, 0
  s_nop 0
  buffer_load_dwordx4 v32, s[8:11], s42 offen lds
  s_add_u32 m0, s94, 4096
  s_nop 0
  buffer_load_dwordx4 v33, s[8:11], s42 offen lds
  s_cmp_eq_u64 s[64:65], 0
  s_cbranch_scc1 Lsk_54
  s_add_u32 m0, s94, 8192
  s_mov_b64 exec, s[64:65]
  buffer_load_dwordx4 v34, s[8:11], s42 offen lds
  s_mov_b64 exec, -1
Lsk_54:
  s_add_u32 s69, s69, 2
  s_cmp_ge_u32 s69, 10
  s_cselect_b32 s39, 10, 0
  s_sub_u32 s69, s69, s39
  s_add_u32 s6, s6, 1
  s_cmp_eq_u32 s6, 5
  s_addc_u32 s69, s69, 0
  s_mul_i32 s42, s69, 128
  s_add_u32 s37, s37, 40960
  s_cmp_ge_u32 s37, 122880
  s_cselect_b32 s37, 0, s37
  s_add_u32 s95, s93, s86
  s_add_u32 m0, s95, 10240
  s_nop 0
  buffer_load_dwordx4 v35, s[12:15], s43 offen lds
  s_add_u32 m0, s95, 14336
  s_nop 0
  buffer_load_dwordx4 v36, s[12:15], s43 offen lds
  s_add_u32 m0, s95, 18432
  s_nop 0
  buffer_load_dwordx4 v37, s[12:15], s43 offen lds
  s_add_u32 m0, s95, 22528
  s_nop 0
  buffer_load_dwordx4 v38, s[12:15], s43 offen lds
  s_add_u32 m0, s95, 26624
  s_nop 0
  buffer_load_dwordx4 v39, s[12:15], s43 offen lds
  s_add_u32 m0, s95, 30720
  s_nop 0
  buffer_load_dwordx4 v40, s[12:15], s43 offen lds
  s_add_u32 m0, s95, 34816
  s_nop 0
  buffer_load_dwordx4 v41, s[12:15], s43 offen lds
  s_cmp_ge_u32 s96, 2
  s_cbranch_scc1 Lskb_55
  s_add_u32 m0, s95, 38912
  s_nop 0
  buffer_load_dwordx4 v42, s[12:15], s43 offen lds
Lskb_55:
  s_add_u32 s92, s92, 2
  s_cmp_ge_u32 s92, 10
  s_cselect_b32 s39, 10, 0
  s_sub_u32 s92, s92, s39
  s_add_u32 s7, s7, 1
  s_cmp_eq_u32 s7, 5
  s_addc_u32 s92, s92, 0
  s_mul_i32 s43, s92, 245760
  s_add_u32 s93, s93, 40960
  s_cmp_ge_u32 s93, 122880
  s_cselect_b32 s93, 0, s93
  s_waitcnt vmcnt(9)
  s_barrier
  s_sub_u32 s38, s38, 1
  s_cmp_lg_u32 s38, 0
  s_cbranch_scc1 Llmain_53
  s_add_u32 s94, s37, s86
  s_add_u32 m0, s94, 0
  s_nop 0
  buffer_load_dwordx4 v32, s[8:11], s42 offen lds
  s_add_u32 m0, s94, 4096
  s_nop 0
  buffer_load_dwordx4 v33, s[8:11], s42 offen lds
  s_cmp_eq_u64 s[64:65], 0
  s_cbranch_scc1 Lsk_56
  s_add_u32 m0, s94, 8192
  s_mov_b64 exec, s[64:65]
  buffer_load_dwordx4 v34, s[8:11], s42 offen lds
  s_mov_b64 exec, -1
Lsk_56:
  s_add_u32 s69, s69, 2
  s_cmp_ge_u32 s69, 10
  s_cselect_b32 s39, 10, 0
  s_sub_u32 s69, s69, s39
  s_add_u32 s6, s6, 1
  s_cmp_eq_u32 s6, 5
  s_addc_u32 s69, s69, 0
  s_mul_i32 s42, s69, 128
  s_add_u32 s37, s37, 40960
  s_cmp_ge_u32 s37, 122880
  s_cselect_b32 s37, 0, s37
  s_add_u32 s95, s93, s86
  s_add_u32 m0, s95, 10240
  s_nop 0
  buffer_load_dwordx4 v35, s[12:15], s43 offen lds
  s_add_u32 m0, s95, 14336
  s_nop 0
  buffer_load_dwordx4 v36, s[12:15], s43 offen lds
  s_add_u32 m0, s95, 18432
  s_nop 0
  buffer_load_dwordx4 v37, s[12:15], s43 offen lds
  s_add_u32 m0, s95, 22528
  s_nop 0
  buffer_load_dwordx4 v38, s[12:15], s43 offen lds
  s_add_u32 m0, s95, 26624
  s_nop 0
  buffer_load_dwordx4 v39, s[12:15], s43 offen lds
  s_add_u32 m0, s95, 30720
  s_nop 0
  buffer_load_dwordx4 v40, s[12:15], s43 offen lds
  s_add_u32 m0, s95, 34816
  s_nop 0
  buffer_load_dwordx4 v41, s[12:15], s43 offen lds
  s_cmp_ge_u32 s96, 2
  s_cbranch_scc1 Lskb_57
  s_add_u32 m0, s95, 38912
  s_nop 0
  buffer_load_dwordx4 v42, s[12:15], s43 offen lds
Lskb_57:
  s_add_u32 s92, s92, 2
  s_cmp_ge_u32 s92, 10
  s_cselect_b32 s39, 10, 0
  s_sub_u32 s92, s92, s39
  s_add_u32 s7, s7, 1
  s_cmp_eq_u32 s7, 5
  s_addc_u32 s92, s92, 0
  s_mul_i32 s43, s92, 245760
  s_add_u32 s93, s93, 40960
  s_cmp_ge_u32 s93, 122880
  s_cselect_b32 s93, 0, s93
  s_add_u32 s28, s62, 0x1880000
  s_addc_u32 s29, s63, 0
  s_and_b32 s29, s29, 0xffff
  s_mov_b32 s30, 0x8000
  s_mov_b32 s31, 0x20000
  s_mov_b32 s24, s60
  s_and_b32 s25, s61, 0xffff
  s_mov_b32 s26, 0x100
  s_mov_b32 s27, 0x20000
  s_lshl_b32 s39, s96, 6
  v_add_u32 v62, s39, v2
  v_add_u32 v63, s34, v62
  v_cmp_gt_u32 vcc, 78, v62
  v_cmp_le_i32 s[4:5], 0, v63
  v_lshlrev_b32 v63, 4, v63
  v_mov_b32 v64, 0x80000000
  s_and_b64 s[98:99], vcc, s[4:5]
  v_mov_b32 v65, 0
  v_cndmask_b32 v63, v64, v63, s[98:99]
  buffer_load_dwordx2 v[60:61], v65, s[24:27], 0 offen sc1
  buffer_load_dwordx4 v[56:59], v63, s[28:31], 0 offen sc1
  s_waitcnt vmcnt(11)
  s_barrier
  s_add_u32 s94, s37, s86
  s_add_u32 m0, s94, 0
  s_nop 0
  buffer_load_dwordx4 v32, s[8:11], s42 offen lds
  s_add_u32 m0, s94, 4096
  s_nop 0
  buffer_load_dwordx4 v33, s[8:11], s42 offen lds
  s_cmp_eq_u64 s[64:65], 0
  s_cbranch_scc1 Lsk_58
  s_add_u32 m0, s94, 8192
  s_mov_b64 exec, s[64:65]
  buffer_load_dwordx4 v34, s[8:11], s42 offen lds
  s_mov_b64 exec, -1
Lsk_58:
  s_add_u32 s69, s69, 2
  s_cmp_ge_u32 s69, 10
  s_cselect_b32 s39, 10, 0
  s_sub_u32 s69, s69, s39
  s_add_u32 s6, s6, 1
  s_cmp_eq_u32 s6, 5
  s_addc_u32 s69, s69, 0
  s_mul_i32 s42, s69, 128
  s_add_u32 s37, s37, 40960
  s_cmp_ge_u32 s37, 122880
  s_cselect_b32 s37, 0, s37
  s_add_u32 s95, s93, s86
  s_add_u32 m0, s95, 10240
  s_nop 0
  buffer_load_dwordx4 v35, s[12:15], s43 offen lds
  s_add_u32 m0, s95, 14336
  s_nop 0
  buffer_load_dwordx4 v36, s[12:15], s43 offen lds
  s_add_u32 m0, s95, 18432
  s_nop 0
  buffer_load_dwordx4 v37, s[12:15], s43 offen lds
  s_add_u32 m0, s95, 22528
  s_nop 0
  buffer_load_dwordx4 v38, s[12:15], s43 offen lds
  s_add_u32 m0, s95, 26624
  s_nop 0
  buffer_load_dwordx4 v39, s[12:15], s43 offen lds
  s_add_u32 m0, s95, 30720
  s_nop 0
  buffer_load_dwordx4 v40, s[12:15], s43 offen lds
  s_add_u32 m0, s95, 34816
  s_nop 0
  buffer_load_dwordx4 v41, s[12:15], s43 offen lds
  s_cmp_ge_u32 s96, 2
  s_cbranch_scc1 Lskb_59
  s_add_u32 m0, s95, 38912
  s_nop 0
  buffer_load_dwordx4 v42, s[12:15], s43 offen lds
Lskb_59:
  s_add_u32 s92, s92, 2
  s_cmp_ge_u32 s92, 10
  s_cselect_b32 s39, 10, 0
  s_sub_u32 s92, s92, s39
  s_add_u32 s7, s7, 1
  s_cmp_eq_u32 s7, 5
  s_addc_u32 s92, s92, 0
  s_mul_i32 s43, s92, 245760
  s_add_u32 s93, s93, 40960
  s_cmp_ge_u32 s93, 122880
  s_cselect_b32 s93, 0, s93
  s_waitcnt vmcnt(11)
  s_barrier
  buffer_load_dwordx4 v[152:155], v150, s[80:83], 0 offen
  v_add_u32 v150, 40960, v150
  buffer_load_dwordx4 v[152:155], v150, s[80:83], 0 offen
  v_add_u32 v150, 40960, v150
  buffer_load_dwordx4 v[152:155], v150, s[80:83], 0 offen
  v_add_u32 v150, 40960, v150
  buffer_load_dwordx4 v[152:155], v150, s[80:83], 0 offen
  v_add_u32 v150, 40960, v150
  buffer_load_dwordx4 v[152:155], v150, s[80:83], 0 offen
  v_add_u32 v150, 40960, v150
  buffer_load_dwordx4 v[152:155], v150, s[80:83], 0 offen
  v_add_u32 v150, 40960, v150
  buffer_load_dwordx4 v[152:155], v150, s[80:83], 0 offen
  s_waitcnt vmcnt(7)
  s_mov_b32 s41, 0x10000
Lp0c_60:
  v_cmp_ne_u64 vcc, v[58:59], v[60:61]
  s_nop 1
  s_and_b64 vcc, vcc, s[98:99]
  s_cbranch_vccz Lp0k_61
  buffer_load_dwordx2 v[60:61], v65, s[24:27], 0 offen sc1
  buffer_load_dwordx4 v[56:59], v63, s[28:31], 0 offen sc1
  s_waitcnt vmcnt(0)
  s_sub_u32 s41, s41, 1
  s_cmp_lg_u32 s41, 0
  s_cbranch_scc1 Lp0c_60
Lp0k_61:
  v_lshlrev_b32 v62, 3, v62
  v_add_u32 v62, 122880, v62
  s_cmp_lt_u32 s96, 2
  s_cselect_b32 exec_lo, -1, 0
  s_cmp_eq_u32 s96, 0
  s_cselect_b32 exec_hi, -1, 0
  s_cmp_eq_u32 s96, 1
  s_cselect_b32 exec_lo, 0xffff, exec_lo
  s_cbranch_execz Lp0w_62
  ds_write_b64 v62, v[56:57]
Lp0w_62:
  s_mov_b64 exec, -1
  s_waitcnt lgkmcnt(0)
  s_barrier
  s_mov_b32 s4, s32
  s_mov_b32 s5, s33
  s_and_b32 s39, s2, 7
  s_lshr_b32 s40, s2, 3
  s_lshl_b32 s39, s39, 5
  s_add_u32 s39, s39, s40
  s_cmp_lt_u32 s39, 243
  s_cselect_b32 s87, 1, 0
  s_cmp_ge_u32 s39, 108
  s_cselect_b32 s40, 108, 0
  s_sub_u32 s41, s39, s40
  s_mul_i32 s33, s41, 16384
  s_lshr_b32 s33, s33, 16
  s_mul_i32 s32, s41, 13108
  s_lshr_b32 s32, s32, 16
  s_cmp_ge_u32 s39, 108
  s_cselect_b32 s33, s32, s33
  s_cselect_b32 s32, 5, 4
  s_mul_i32 s32, s32, s33
  s_sub_u32 s32, s41, s32
  s_cmp_ge_u32 s39, 108
  s_cselect_b32 s40, 4, 0
  s_add_u32 s32, s32, s40
  s_mul_i32 s39, s32, 16384
  s_lshr_b32 s39, s39, 16
  s_mul_i32 s39, s39, 4
  s_sub_u32 s39, s32, s39
  s_mul_i32 s39, s39, 160
  s_lshl_b32 s40, s96, 3
  s_add_u32 s39, s39, s40
  v_lshrrev_b32 v150, 3, v2
  v_add_u32 v150, s39, v150
  s_mov_b32 s40, 3456
  v_mul_lo_u32 v150, v150, s40
  v_and_b32 v151, 7, v2
  v_lshl_add_u32 v150, v151, 4, v150
  s_mul_i32 s40, s33, 128
  v_add_u32 v150, s40, v150
  s_cmp_eq_u32 s87, 0
  s_cselect_b32 s40, 0x80000000, 0
  v_or_b32 v150, s40, v150
  s_mov_b32 s80, s52
  s_mov_b32 s81, s53
  s_and_b32 s81, s81, 0xffff
  s_mov_b32 s82, 0x21c000
  s_mov_b32 s83, 0x20000
  s_mov_b32 s32, s4
  s_mov_b32 s33, s5
  buffer_load_dwordx4 v[152:155], v150, s[80:83], 0 offen
  v_add_u32 v150, 110592, v150
  buffer_load_dwordx4 v[152:155], v150, s[80:83], 0 offen
  v_add_u32 v150, 110592, v150
  buffer_load_dwordx4 v[152:155], v150, s[80:83], 0 offen
  v_add_u32 v150, 110592, v150
  buffer_load_dwordx4 v[152:155], v150, s[80:83], 0 offen
  v_add_u32 v150, 110592, v150
  buffer_load_dwordx4 v[152:155], v150, s[80:83], 0 offen
  s_barrier
L_att_start:
  ds_read_b64 v[16:17], v144 offset:0
  ds_read_b64 v[18:19], v144 offset:8
  ds_read_b64 v[20:21], v144 offset:16
  ds_read_b64 v[22:23], v144 offset:24
  ds_read_b64 v[24:25], v144 offset:32
  ds_read_b64 v[32:33], v145 offset:0
  ds_read_b64 v[34:35], v145 offset:8
  ds_read_b64 v[36:37], v145 offset:16
  ds_read_b64 v[38:39], v145 offset:24
  ds_read_b64 v[40:41], v145 offset:32
  ds_read_b64 v[42:43], v145 offset:3904
  ds_read_b64 v[44:45], v145 offset:3912
  ds_read_b64 v[46:47], v145 offset:3920
  ds_read_b64 v[48:49], v145 offset:3928
  ds_read_b64 v[50:51], v145 offset:3936
  ds_read_b64 v[52:53], v146 offset:0
  ds_read_b64 v[54:55], v146 offset:8
  ds_read_b64 v[56:57], v146 offset:16
  ds_read_b64 v[58:59], v146 offset:24
  ds_read_b64 v[60:61], v146 offset:32
  s_mov_b32 s41, 0x3ea52b5c
  s_waitcnt lgkmcnt(0)
  ds_read_b64_tr_b16 v[62:63], v147 offset:0
  ds_read_b64_tr_b16 v[64:65], v147 offset:8
  ds_read_b64_tr_b16 v[66:67], v147 offset:16
  ds_read_b64_tr_b16 v[68:69], v147 offset:24
  ds_read_b64_tr_b16 v[70:71], v147 offset:32
  ds_read_b64_tr_b16 v[72:73], v147 offset:3904
  ds_read_b64_tr_b16 v[74:75], v147 offset:3912
  ds_read_b64_tr_b16 v[76:77], v147 offset:3920
  ds_read_b64_tr_b16 v[78:79], v147 offset:3928
  ds_read_b64_tr_b16 v[80:81], v147 offset:3936
  ds_read_b64_tr_b16 v[82:83], v119 offset:0
  ds_read_b64_tr_b16 v[84:85], v119 offset:8
  ds_read_b64_tr_b16 v[86:87], v119 offset:16
  ds_read_b64_tr_b16 v[88:89], v119 offset:24
  ds_read_b64_tr_b16 v[90:91], v119 offset:32
  v_mfma_f32_4x4x4_16b_bf16 v[92:95], v[32:33], v[16:17], 0
  v_mfma_f32_4x4x4_16b_bf16 v[96:99], v[42:43], v[16:17], 0
  v_mfma_f32_4x4x4_16b_bf16 v[100:103], v[52:53], v[16:17], 0
  v_mfma_f32_4x4x4_16b_bf16 v[92:95], v[34:35], v[18:19], v[92:95]
  v_mfma_f32_4x4x4_16b_bf16 v[96:99], v[44:45], v[18:19], v[96:99]
  v_mfma_f32_4x4x4_16b_bf16 v[100:103], v[54:55], v[18:19], v[100:103]
  v_mfma_f32_4x4x4_16b_bf16 v[92:95], v[36:37], v[20:21], v[92:95]
  v_mfma_f32_4x4x4_16b_bf16 v[96:99], v[46:47], v[20:21], v[96:99]
  v_mfma_f32_4x4x4_16b_bf16 v[100:103], v[56:57], v[20:21], v[100:103]
  v_mfma_f32_4x4x4_16b_bf16 v[92:95], v[38:39], v[22:23], v[92:95]
  v_mfma_f32_4x4x4_16b_bf16 v[96:99], v[48:49], v[22:23], v[96:99]
  v_mfma_f32_4x4x4_16b_bf16 v[100:103], v[58:59], v[22:23], v[100:103]
  v_mfma_f32_4x4x4_16b_bf16 v[92:95], v[40:41], v[24:25], v[92:95]
  v_mfma_f32_4x4x4_16b_bf16 v[96:99], v[50:51], v[24:25], v[96:99]
  v_mfma_f32_4x4x4_16b_bf16 v[100:103], v[60:61], v[24:25], v[100:103]
  s_nop 4
  v_fma_f32 v92, v92, s41, v120
  v_fma_f32 v93, v93, s41, v121
  v_fma_f32 v94, v94, s41, v122
  v_fma_f32 v95, v95, s41, v123
  v_fma_f32 v96, v96, s41, v124
  v_fma_f32 v97, v97, s41, v125
  v_fma_f32 v98, v98, s41, v126
  v_fma_f32 v99, v99, s41, v127
  v_fma_f32 v100, v100, s41, v128
  v_fma_f32 v101, v101, s41, v129
  v_fma_f32 v102, v102, s41, v130
  v_fma_f32 v103, v103, s41, v131
  v_max3_f32 v14, v92, v93, v94
  v_max3_f32 v15, v95, v96, v97
  v_max3_f32 v14, v14, v98, v99
  v_max3_f32 v15, v15, v100, v101
  v_max3_f32 v14, v14, v102, v103
  v_max_f32 v14, v14, v15
  v_sub_f32 v92, v92, v14
  v_sub_f32 v93, v93, v14
  v_sub_f32 v94, v94, v14
  v_sub_f32 v95, v95, v14
  v_sub_f32 v96, v96, v14
  v_sub_f32 v97, v97, v14
  v_sub_f32 v98, v98, v14
  v_sub_f32 v99, v99, v14
  v_sub_f32 v100, v100, v14
  v_sub_f32 v101, v101, v14
  v_sub_f32 v102, v102, v14
  v_sub_f32 v103, v103, v14
  v_exp_f32 v92, v92
  v_exp_f32 v93, v93
  v_exp_f32 v94, v94
  v_exp_f32 v95, v95
  v_exp_f32 v96, v96
  v_exp_f32 v97, v97
  v_exp_f32 v98, v98
  v_exp_f32 v99, v99
  v_exp_f32 v100, v100
  v_exp_f32 v101, v101
  v_exp_f32 v102, v102
  v_exp_f32 v103, v103
  v_add_f32 v14, v92, v93
  v_add_f32 v15, v94, v95
  v_add_f32 v14, v14, v96
  v_add_f32 v15, v15, v97
  v_add_f32 v14, v14, v98
  v_add_f32 v15, v15, v99
  v_add_f32 v14, v14, v100
  v_add_f32 v15, v15, v101
  v_add_f32 v14, v14, v102
  v_add_f32 v15, v15, v103
  v_add_f32 v14, v14, v15
  v_rcp_f32 v14, v14
  s_nop 0
  v_mul_f32 v92, v92, v14
  v_mul_f32 v93, v93, v14
  v_mul_f32 v94, v94, v14
  v_mul_f32 v95, v95, v14
  v_mul_f32 v96, v96, v14
  v_mul_f32 v97, v97, v14
  v_mul_f32 v98, v98, v14
  v_mul_f32 v99, v99, v14
  v_mul_f32 v100, v100, v14
  v_mul_f32 v101, v101, v14
  v_mul_f32 v102, v102, v14
  v_mul_f32 v103, v103, v14
  v_cvt_pk_bf16_f32 v104, v92, v93
  v_cvt_pk_bf16_f32 v105, v94, v95
  v_cvt_pk_bf16_f32 v106, v96, v97
  v_cvt_pk_bf16_f32 v107, v98, v99
  v_cvt_pk_bf16_f32 v108, v100, v101
  v_cvt_pk_bf16_f32 v109, v102, v103
  s_waitcnt lgkmcnt(0)
  s_nop 0
  v_mfma_f32_4x4x4_16b_bf16 v[32:35], v[62:63], v[104:105], 0
  v_mfma_f32_4x4x4_16b_bf16 v[36:39], v[64:65], v[104:105], 0
  v_mfma_f32_4x4x4_16b_bf16 v[40:43], v[66:67], v[104:105], 0
  v_mfma_f32_4x4x4_16b_bf16 v[44:47], v[68:69], v[104:105], 0
  v_mfma_f32_4x4x4_16b_bf16 v[48:51], v[70:71], v[104:105], 0
  v_mfma_f32_4x4x4_16b_bf16 v[32:35], v[72:73], v[106:107], v[32:35]
  v_mfma_f32_4x4x4_16b_bf16 v[36:39], v[74:75], v[106:107], v[36:39]
  v_mfma_f32_4x4x4_16b_bf16 v[40:43], v[76:77], v[106:107], v[40:43]
  v_mfma_f32_4x4x4_16b_bf16 v[44:47], v[78:79], v[106:107], v[44:47]
  v_mfma_f32_4x4x4_16b_bf16 v[48:51], v[80:81], v[106:107], v[48:51]
  v_mfma_f32_4x4x4_16b_bf16 v[32:35], v[82:83], v[108:109], v[32:35]
  v_mfma_f32_4x4x4_16b_bf16 v[36:39], v[84:85], v[108:109], v[36:39]
  v_mfma_f32_4x4x4_16b_bf16 v[40:43], v[86:87], v[108:109], v[40:43]
  v_mfma_f32_4x4x4_16b_bf16 v[44:47], v[88:89], v[108:109], v[44:47]
  v_mfma_f32_4x4x4_16b_bf16 v[48:51], v[90:91], v[108:109], v[48:51]
  s_nop 5
  v_cvt_pk_bf16_f32 v16, v32, v33
  v_cvt_pk_bf16_f32 v17, v34, v35
  ds_write_b64 v118, v[16:17] offset:0
  v_cvt_pk_bf16_f32 v18, v36, v37
  v_cvt_pk_bf16_f32 v19, v38, v39
  ds_write_b64 v118, v[18:19] offset:8
  v_cvt_pk_bf16_f32 v20, v40, v41
  v_cvt_pk_bf16_f32 v21, v42, v43
  ds_write_b64 v118, v[20:21] offset:16
  v_cvt_pk_bf16_f32 v22, v44, v45
  v_cvt_pk_bf16_f32 v23, v46, v47
  ds_write_b64 v118, v[22:23] offset:24
  v_cvt_pk_bf16_f32 v24, v48, v49
  v_cvt_pk_bf16_f32 v25, v50, v51
  ds_write_b64 v118, v[24:25] offset:32
  s_waitcnt lgkmcnt(0)
  s_barrier
  ds_read_b128 v[20:23], v148
  s_cmp_ge_u32 s36, 2
  s_cbranch_scc1 Lost_63
  ds_read_b128 v[24:27], v149
  s_waitcnt lgkmcnt(0)
  buffer_store_dwordx4 v[24:27], v157, s[20:23], 0 offen sc1
Lost_63:
  s_waitcnt lgkmcnt(0)
  buffer_store_dwordx4 v[20:23], v156, s[20:23], 0 offen sc1
  s_lshl_b32 s85, s32, 3
  s_add_u32 s85, s85, s33
  s_lshl_b32 s85, s85, 7
  s_add_u32 s85, s85, 0x8000
  s_waitcnt vmcnt(0)
  s_barrier
  s_branch Lnext_46
Linv_47:
  s_waitcnt lgkmcnt(0)
  s_add_u32 s88, s62, 0x1900000
  s_addc_u32 s89, s63, 0
  s_and_b32 s89, s89, 0xffff
  s_mov_b32 s90, 0x20000
  s_mov_b32 s91, 0x20000
Lnext_46:
  s_and_b32 s39, s2, 7
  s_lshr_b32 s40, s2, 3
  s_lshl_b32 s39, s39, 5
  s_add_u32 s39, s39, s40
  s_cmp_lt_u32 s39, 250
  s_cselect_b32 s87, 1, 0
  s_mul_i32 s32, s39, 6554
  s_lshr_b32 s32, s32, 16
  s_mul_i32 s33, s32, 10
  s_sub_u32 s33, s39, s33
  s_cmp_eq_u32 s87, 0
  s_cbranch_scc1 Linv_65
  s_mul_i32 s34, s32, 82
  s_mul_i32 s35, s33, 64
  s_add_u32 s68, s34, 82
  s_min_u32 s68, s68, 2048
  v_lshrrev_b32 v3, 3, v2
  v_and_b32 v4, 7, v2
  v_lshrrev_b32 v5, 1, v3
  v_xor_b32 v6, v4, v5
  v_lshlrev_b32 v6, 4, v6
  s_lshl_b32 s39, s96, 3
  s_add_u32 s39, s39, s34
  v_add_u32 v7, s39, v3
  s_mov_b32 s39, 1024
  v_mul_lo_u32 v7, v7, s39
  v_add_u32 v7, v7, v6
  s_and_b32 s39, s96, 1
  s_lshl_b32 s39, s39, 6
  v_xor_b32 v7, s39, v7
  v_add_u32 v32, 0, v7
  v_add_u32 v33, 32768, v7
  v_add_u32 v34, 65536, v7
  v_and_b32 v8, 1, v5
  v_lshlrev_b32 v8, 1, v8
  v_xor_b32 v8, v4, v8
  v_lshlrev_b32 v8, 4, v8
  s_lshl_b32 s39, s96, 3
  v_add_u32 v9, s39, v3
  s_mov_b32 s39, 1280
  v_mul_lo_u32 v9, v9, s39
  v_add_u32 v9, v9, v8
  s_and_b32 s39, s96, 1
  s_lshl_b32 s39, s39, 6
  v_xor_b32 v9, s39, v9
  s_lshl_b32 s40, s35, 1
  v_add_u32 v9, s40, v9
  v_add_u32 v35, 0, v9
  v_add_u32 v36, 40960, v9
  s_and_b32 s39, s96, 1
  s_lshl_b32 s39, s39, 6
  v_xor_b32 v10, s39, v6
  v_lshrrev_b32 v11, 5, v10
  v_lshlrev_b32 v11, 7, v11
  v_and_b32 v12, 16, v10
  v_add_u32 v11, v11, v12
  s_lshl_b32 s39, s96, 3
  s_add_u32 s39, s39, s34
  v_add_u32 v12, s39, v3
  v_add_u32 v13, 0, v12
  v_lshrrev_b32 v14, 2, v13
  v_lshlrev_b32 v14, 10, v14
  v_and_b32 v13, 3, v13
  v_lshl_add_u32 v14, v13, 5, v14
  v_add_u32 v14, v14, v11
  v_add_u32 v44, 0x200000, v14
  v_add_u32 v13, 32, v12
  v_lshrrev_b32 v14, 2, v13
  v_lshlrev_b32 v14, 10, v14
  v_and_b32 v13, 3, v13
  v_lshl_add_u32 v14, v13, 5, v14
  v_add_u32 v14, v14, v11
  v_add_u32 v45, 0x200000, v14
  v_add_u32 v13, 64, v12
  v_lshrrev_b32 v14, 2, v13
  v_lshlrev_b32 v14, 10, v14
  v_and_b32 v13, 3, v13
  v_lshl_add_u32 v14, v13, 5, v14
  v_add_u32 v14, v14, v11
  v_add_u32 v46, 0x200000, v14
  s_and_b32 s39, s96, 1
  s_lshl_b32 s39, s39, 6
  v_xor_b32 v10, s39, v8
  s_lshl_b32 s40, s35, 1
  v_add_u32 v10, s40, v10
  s_lshl_b32 s39, s96, 3
  v_add_u32 v12, s39, v3
  v_add_u32 v12, 0, v12
  v_lshrrev_b32 v13, 4, v12
  v_mul_u32_u24 v13, 80, v13
  v_and_b32 v12, 15, v12
  v_add_u32 v13, v13, v12
  v_add_u32 v13, 64, v13
  v_mul_u32_u24 v13, 1280, v13
  v_add_u32 v47, v13, v10
  v_add_u32 v12, s39, v3
  v_add_u32 v12, 32, v12
  v_lshrrev_b32 v13, 4, v12
  v_mul_u32_u24 v13, 80, v13
  v_and_b32 v12, 15, v12
  v_add_u32 v13, v13, v12
  v_add_u32 v13, 64, v13
  v_mul_u32_u24 v13, 1280, v13
  v_add_u32 v48, v13, v10
  s_lshl_b32 s86, s96, 10
  s_cmp_lt_u32 s96, 2
  s_cselect_b32 s64, -1, 0xffff
  s_cselect_b32 s65, -1, 0
  s_cmp_eq_u32 s96, 3
  s_cselect_b32 s64, 0, s64
  s_mul_i32 s69, s33, 2
  s_mul_i32 s39, s32, 13
  s_add_u32 s69, s69, s39
  s_lshr_b32 s69, s69, 2
  s_mul_i32 s39, s69, 8192
  s_lshr_b32 s39, s39, 16
  s_mul_i32 s39, s39, 8
  s_sub_u32 s69, s69, s39
  s_mov_b32 s92, s69
  s_mov_b32 s6, 0
  s_mov_b32 s7, 0
  s_add_u32 s8, s62, 0x800000
  s_addc_u32 s9, s63, 0
  s_and_b32 s9, s9, 0xffff
  s_mov_b32 s10, 0x280000
  s_mov_b32 s11, 0x20000
  s_mov_b32 s12, s48
  s_mov_b32 s13, s49
  s_and_b32 s13, s13, 0xffff
  s_mov_b32 s14, 0xc8000
  s_mov_b32 s15, 0x20000
  s_add_u32 s20, s62, 0xb00000
  s_addc_u32 s21, s63, 0
  s_and_b32 s21, s21, 0xffff
  s_mov_b32 s22, 0x280000
  s_mov_b32 s23, 0x20000
  s_mov_b32 s24, s44
  s_mov_b32 s25, s45
  s_and_b32 s25, s25, 0xffff
  s_mov_b32 s26, 0x280000
  s_mov_b32 s27, 0x20000
  s_add_u32 s28, s62, 0x1800000
  s_addc_u32 s29, s63, 0
  s_and_b32 s29, s29, 0xffff
  s_mov_b32 s30, 0x5dc00
  s_mov_b32 s31, 0x20000
  s_mov_b32 s37, 0
  s_mov_b32 s93, 0
  s_mul_i32 s42, s69, 128
  s_mul_i32 s43, s92, 102400
  s_mov_b32 s38, 8
Lbpre_66:
  s_add_u32 s95, s93, s86
  s_add_u32 m0, s95, 73728
  s_nop 0
  buffer_load_dwordx4 v35, s[12:15], s43 offen lds
  s_add_u32 m0, s95, 77824
  s_nop 0
  buffer_load_dwordx4 v36, s[12:15], s43 offen lds
  s_add_u32 s92, s92, 1
  s_cmp_ge_u32 s92, 8
  s_cselect_b32 s92, 0, s92
  s_mul_i32 s43, s92, 102400
  s_add_u32 s93, s93, 8192
  s_cmp_ge_u32 s93, 81920
  s_cselect_b32 s93, 0, s93
  s_sub_u32 s38, s38, 1
  s_cmp_lg_u32 s38, 0
  s_cbranch_scc1 Lbpre_66
  s_add_u32 s95, s93, s86
  s_mov_b32 s43, 0
  s_add_u32 m0, s95, 73728
  s_nop 0
  buffer_load_dwordx4 v47, s[12:15], s43 offen lds
  s_add_u32 m0, s95, 77824
  s_nop 0
  buffer_load_dwordx4 v48, s[12:15], s43 offen lds
  s_add_u32 s93, s93, 8192
  s_cmp_ge_u32 s93, 81920
  s_cselect_b32 s93, 0, s93
  s_add_u32 s95, s93, s86
  s_mov_b32 s43, 409600
  s_add_u32 m0, s95, 73728
  s_nop 0
  buffer_load_dwordx4 v47, s[12:15], s43 offen lds
  s_add_u32 m0, s95, 77824
  s_nop 0
  buffer_load_dwordx4 v48, s[12:15], s43 offen lds
  s_add_u32 s93, s93, 8192
  s_cmp_ge_u32 s93, 81920
  s_cselect_b32 s93, 0, s93
  s_barrier
  s_add_u32 s94, s37, s86
  s_add_u32 m0, s94, 0
  s_nop 0
  buffer_load_dwordx4 v32, s[8:11], s42 offen sc1 lds
  s_add_u32 m0, s94, 4096
  s_nop 0
  buffer_load_dwordx4 v33, s[8:11], s42 offen sc1 lds
  s_cmp_eq_u64 s[64:65], 0
  s_cbranch_scc1 Lsk_67
  s_add_u32 m0, s94, 8192
  s_mov_b64 exec, s[64:65]
  buffer_load_dwordx4 v34, s[8:11], s42 offen sc1 lds
  s_mov_b64 exec, -1
Lsk_67:
  s_add_u32 s69, s69, 1
  s_cmp_ge_u32 s69, 8
  s_cselect_b32 s69, 0, s69
  s_mul_i32 s42, s69, 128
  s_add_u32 s37, s37, 12288
  s_cmp_ge_u32 s37, 73728
  s_cselect_b32 s37, 0, s37
  s_add_u32 s94, s37, s86
  s_add_u32 m0, s94, 0
  s_nop 0
  buffer_load_dwordx4 v32, s[8:11], s42 offen sc1 lds
  s_add_u32 m0, s94, 4096
  s_nop 0
  buffer_load_dwordx4 v33, s[8:11], s42 offen sc1 lds
  s_cmp_eq_u64 s[64:65], 0
  s_cbranch_scc1 Lsk_68
  s_add_u32 m0, s94, 8192
  s_mov_b64 exec, s[64:65]
  buffer_load_dwordx4 v34, s[8:11], s42 offen sc1 lds
  s_mov_b64 exec, -1
Lsk_68:
  s_add_u32 s69, s69, 1
  s_cmp_ge_u32 s69, 8
  s_cselect_b32 s69, 0, s69
  s_mul_i32 s42, s69, 128
  s_add_u32 s37, s37, 12288
  s_cmp_ge_u32 s37, 73728
  s_cselect_b32 s37, 0, s37
  v_mov_b32 v12, 0
  v_mov_b32 v13, 0
  v_mov_b32 v14, 0
  v_mov_b32 v15, 0
  v_mov_b32 v10, 0x3f803f80
  v_lshlrev_b32 v11, 4, v2
  s_add_u32 s39, s96, 0
  s_cmp_ge_u32 s39, 6
  s_cbranch_scc1 Lpad_69
  s_mul_i32 s39, s39, 12288
  v_add_u32 v16, s39, v11
  ds_write_b128 v16, v[12:15] offset:10496
  v_add_u32 v16, s39, v11
  s_mov_b32 exec_lo, 0xffffffff
  s_mov_b32 exec_hi, 0xffff
  ds_write_b128 v16, v[12:15] offset:11520
  s_mov_b64 exec, -1
Lpad_69:
  s_add_u32 s39, s96, 4
  s_cmp_ge_u32 s39, 6
  s_cbranch_scc1 Lpad_70
  s_mul_i32 s39, s39, 12288
  v_add_u32 v16, s39, v11
  ds_write_b128 v16, v[12:15] offset:10496
  v_add_u32 v16, s39, v11
  s_mov_b32 exec_lo, 0xffffffff
  s_mov_b32 exec_hi, 0xffff
  ds_write_b128 v16, v[12:15] offset:11520
  s_mov_b64 exec, -1
Lpad_70:
  s_mov_b32 s4, s32
  s_mov_b32 s5, s33
  s_and_b32 s39, s2, 7
  s_lshr_b32 s40, s2, 3
  s_lshl_b32 s39, s39, 5
  s_add_u32 s39, s39, s40
  s_cmp_lt_u32 s39, 243
  s_cselect_b32 s87, 1, 0
  s_cmp_ge_u32 s39, 108
  s_cselect_b32 s40, 108, 0
  s_sub_u32 s41, s39, s40
  s_mul_i32 s33, s41, 16384
  s_lshr_b32 s33, s33, 16
  s_mul_i32 s32, s41, 13108
  s_lshr_b32 s32, s32, 16
  s_cmp_ge_u32 s39, 108
  s_cselect_b32 s33, s32, s33
  s_cselect_b32 s32, 5, 4
  s_mul_i32 s32, s32, s33
  s_sub_u32 s32, s41, s32
  s_cmp_ge_u32 s39, 108
  s_cselect_b32 s40, 4, 0
  s_add_u32 s32, s32, s40
  s_mul_i32 s39, s32, 16384
  s_lshr_b32 s39, s39, 16
  s_mul_i32 s39, s39, 4
  s_sub_u32 s39, s32, s39
  s_mul_i32 s39, s39, 160
  s_lshl_b32 s40, s96, 3
  s_add_u32 s39, s39, s40
  v_lshrrev_b32 v150, 3, v2
  v_add_u32 v150, s39, v150
  s_mov_b32 s40, 3456
  v_mul_lo_u32 v150, v150, s40
  v_and_b32 v151, 7, v2
  v_lshl_add_u32 v150, v151, 4, v150
  s_mul_i32 s40, s33, 128
  v_add_u32 v150, s40, v150
  s_cmp_eq_u32 s87, 0
  s_cselect_b32 s40, 0x80000000, 0
  v_or_b32 v150, s40, v150
  s_mov_b32 s80, s54
  s_mov_b32 s81, s55
  s_and_b32 s81, s81, 0xffff
  s_mov_b32 s82, 0x21c000
  s_mov_b32 s83, 0x20000
  s_mov_b32 s32, s4
  s_mov_b32 s33, s5
  v_lshrrev_b32 v112, 3, v2
  v_and_b32 v113, 7, v2
  v_xor_b32 v108, v113, v112
  v_lshlrev_b32 v108, 4, v108
  v_lshl_add_u32 v108, v112, 7, v108
  s_lshl_b32 s39, s36, 10
  s_add_u32 s39, s39, 0
  v_add_u32 v108, s39, v108
  s_lshl_b32 s39, s36, 3
  s_add_u32 s39, s39, s34
  v_add_u32 v111, s39, v112
  v_mul_u32_u24 v109, 1280, v111
  s_lshl_b32 s39, s35, 1
  v_lshl_add_u32 v109, v113, 4, v109
  v_add_u32 v109, s39, v109
  v_add_u32 v110, 81920, v109
  v_mov_b32 v114, 0x80000000
  v_cmp_gt_u32 vcc, s68, v111
  v_add_u32 v115, 64, v111
  s_nop 0
  v_cndmask_b32 v109, v114, v109, vcc
  v_cmp_gt_u32 vcc, s68, v115
  s_nop 1
  v_cndmask_b32 v110, v114, v110, vcc
  buffer_load_dwordx4 v[100:103], v109, s[24:27], 0 offen
  buffer_load_dwordx4 v[104:107], v110, s[24:27], 0 offen
  s_waitcnt vmcnt(4)
  s_waitcnt lgkmcnt(0)
  s_barrier
  s_add_u32 s94, s37, s86
  s_add_u32 m0, s94, 0
  s_nop 0
  buffer_load_dwordx4 v32, s[8:11], s42 offen sc1 lds
  s_add_u32 m0, s94, 4096
  s_nop 0
  buffer_load_dwordx4 v33, s[8:11], s42 offen sc1 lds
  s_cmp_eq_u64 s[64:65], 0
  s_cbranch_scc1 Lsk_71
  s_add_u32 m0, s94, 8192
  s_mov_b64 exec, s[64:65]
  buffer_load_dwordx4 v34, s[8:11], s42 offen sc1 lds
  s_mov_b64 exec, -1
Lsk_71:
  s_add_u32 s69, s69, 1
  s_cmp_ge_u32 s69, 8
  s_cselect_b32 s69, 0, s69
  s_mul_i32 s42, s69, 128
  s_add_u32 s37, s37, 12288
  s_cmp_ge_u32 s37, 73728
  s_cselect_b32 s37, 0, s37
  s_add_u32 s94, s37, s86
  s_add_u32 m0, s94, 0
  s_nop 0
  buffer_load_dwordx4 v32, s[8:11], s42 offen sc1 lds
  s_add_u32 m0, s94, 4096
  s_nop 0
  buffer_load_dwordx4 v33, s[8:11], s42 offen sc1 lds
  s_cmp_eq_u64 s[64:65], 0
  s_cbranch_scc1 Lsk_72
  s_add_u32 m0, s94, 8192
  s_mov_b64 exec, s[64:65]
  buffer_load_dwordx4 v34, s[8:11], s42 offen sc1 lds
  s_mov_b64 exec, -1
Lsk_72:
  s_add_u32 s69, s69, 1
  s_cmp_ge_u32 s69, 8
  s_cselect_b32 s69, 0, s69
  s_mul_i32 s42, s69, 128
  s_add_u32 s37, s37, 12288
  s_cmp_ge_u32 s37, 73728
  s_cselect_b32 s37, 0, s37
  s_waitcnt vmcnt(6)
  s_barrier
  s_add_u32 s94, s37, s86
  s_add_u32 m0, s94, 0
  s_nop 0
  buffer_load_dwordx4 v32, s[8:11], s42 offen sc1 lds
  s_add_u32 m0, s94, 4096
  s_nop 0
  buffer_load_dwordx4 v33, s[8:11], s42 offen sc1 lds
  s_cmp_eq_u64 s[64:65], 0
  s_cbranch_scc1 Lsk_73
  s_add_u32 m0, s94, 8192
  s_mov_b64 exec, s[64:65]
  buffer_load_dwordx4 v34, s[8:11], s42 offen sc1 lds
  s_mov_b64 exec, -1
Lsk_73:
  s_add_u32 s69, s69, 1
  s_cmp_ge_u32 s69, 8
  s_cselect_b32 s69, 0, s69
  s_mul_i32 s42, s69, 128
  s_add_u32 s37, s37, 12288
  s_cmp_ge_u32 s37, 73728
  s_cselect_b32 s37, 0, s37
  s_add_u32 s94, s37, s86
  s_add_u32 m0, s94, 0
  s_nop 0
  buffer_load_dwordx4 v32, s[8:11], s42 offen sc1 lds
  s_add_u32 m0, s94, 4096
  s_nop 0
  buffer_load_dwordx4 v33, s[8:11], s42 offen sc1 lds
  s_cmp_eq_u64 s[64:65], 0
  s_cbranch_scc1 Lsk_74
  s_add_u32 m0, s94, 8192
  s_mov_b64 exec, s[64:65]
  buffer_load_dwordx4 v34, s[8:11], s42 offen sc1 lds
  s_mov_b64 exec, -1
Lsk_74:
  s_add_u32 s69, s69, 1
  s_cmp_ge_u32 s69, 8
  s_cselect_b32 s69, 0, s69
  s_mul_i32 s42, s69, 128
  s_add_u32 s37, s37, 12288
  s_cmp_ge_u32 s37, 73728
  s_cselect_b32 s37, 0, s37
  s_waitcnt vmcnt(6)
  s_barrier
  s_add_u32 s94, s37, s86
  s_add_u32 m0, s94, 0
  s_nop 0
  buffer_load_dwordx4 v32, s[8:11], s42 offen sc1 lds
  s_add_u32 m0, s94, 4096
  s_nop 0
  buffer_load_dwordx4 v33, s[8:11], s42 offen sc1 lds
  s_cmp_eq_u64 s[64:65], 0
  s_cbranch_scc1 Lsk_75
  s_add_u32 m0, s94, 8192
  s_mov_b64 exec, s[64:65]
  buffer_load_dwordx4 v34, s[8:11], s42 offen sc1 lds
  s_mov_b64 exec, -1
Lsk_75:
  s_add_u32 s69, s69, 1
  s_cmp_ge_u32 s69, 8
  s_cselect_b32 s69, 0, s69
  s_mul_i32 s42, s69, 128
  s_add_u32 s37, s37, 12288
  s_cmp_ge_u32 s37, 73728
  s_cselect_b32 s37, 0, s37
  s_add_u32 s94, s37, s86
  s_add_u32 m0, s94, 0
  s_nop 0
  buffer_load_dwordx4 v32, s[8:11], s42 offen sc1 lds
  s_add_u32 m0, s94, 4096
  s_nop 0
  buffer_load_dwordx4 v33, s[8:11], s42 offen sc1 lds
  s_cmp_eq_u64 s[64:65], 0
  s_cbranch_scc1 Lsk_76
  s_add_u32 m0, s94, 8192
  s_mov_b64 exec, s[64:65]
  buffer_load_dwordx4 v34, s[8:11], s42 offen sc1 lds
  s_mov_b64 exec, -1
Lsk_76:
  s_add_u32 s69, s69, 1
  s_cmp_ge_u32 s69, 8
  s_cselect_b32 s69, 0, s69
  s_mul_i32 s42, s69, 128
  s_add_u32 s37, s37, 12288
  s_cmp_ge_u32 s37, 73728
  s_cselect_b32 s37, 0, s37
  s_waitcnt vmcnt(8)
  s_barrier
  s_add_u32 s94, s37, s86
  s_mov_b32 s42, 0
  s_add_u32 m0, s94, 0
  s_nop 0
  buffer_load_dwordx4 v44, s[8:11], s42 offen sc1 lds
  s_add_u32 m0, s94, 4096
  s_nop 0
  buffer_load_dwordx4 v45, s[8:11], s42 offen sc1 lds
  s_cmp_eq_u64 s[64:65], 0
  s_cbranch_scc1 Lsk_77
  s_add_u32 m0, s94, 8192
  s_mov_b64 exec, s[64:65]
  buffer_load_dwordx4 v46, s[8:11], s42 offen sc1 lds
  s_mov_b64 exec, -1
Lsk_77:
  s_add_u32 s37, s37, 12288
  s_cmp_ge_u32 s37, 73728
  s_cselect_b32 s37, 0, s37
  s_waitcnt vmcnt(8)
  s_barrier
  s_add_u32 s94, s37, s86
  s_mov_b32 s42, 512
  s_add_u32 m0, s94, 0
  s_nop 0
  buffer_load_dwordx4 v44, s[8:11], s42 offen sc1 lds
  s_add_u32 m0, s94, 4096
  s_nop 0
  buffer_load_dwordx4 v45, s[8:11], s42 offen sc1 lds
  s_cmp_eq_u64 s[64:65], 0
  s_cbranch_scc1 Lsk_78
  s_add_u32 m0, s94, 8192
  s_mov_b64 exec, s[64:65]
  buffer_load_dwordx4 v46, s[8:11], s42 offen sc1 lds
  s_mov_b64 exec, -1
Lsk_78:
  s_add_u32 s37, s37, 12288
  s_cmp_ge_u32 s37, 73728
  s_cselect_b32 s37, 0, s37
  s_waitcnt vmcnt(8)
  s_barrier
  s_waitcnt vmcnt(6)
  s_barrier
  s_waitcnt vmcnt(4)
  s_barrier
  buffer_load_dwordx4 v[152:155], v150, s[80:83], 0 offen
  v_add_u32 v150, 110592, v150
  buffer_load_dwordx4 v[152:155], v150, s[80:83], 0 offen
  v_add_u32 v150, 110592, v150
  buffer_load_dwordx4 v[152:155], v150, s[80:83], 0 offen
  v_add_u32 v150, 110592, v150
  buffer_load_dwordx4 v[152:155], v150, s[80:83], 0 offen
  v_add_u32 v150, 110592, v150
  buffer_load_dwordx4 v[152:155], v150, s[80:83], 0 offen
  s_waitcnt vmcnt(7)
  s_barrier
  s_waitcnt vmcnt(5)
  s_barrier
  s_barrier
  ds_read_b128 v[16:19], v108 offset:0
  ds_read_b128 v[20:23], v108 offset:8192
  v_mov_b32 v26, 0x3f803f80
  s_waitcnt vmcnt(0) lgkmcnt(0)
  v_lshlrev_b32 v28, 16, v16
  v_and_b32 v29, 0xffff0000, v16
  v_lshlrev_b32 v30, 16, v100
  v_and_b32 v31, 0xffff0000, v100
  v_pk_add_f32 v[28:29], v[28:29], v[30:31]
  v_cvt_pk_bf16_f32 v16, v28, v29
  v_lshlrev_b32 v28, 16, v17
  v_and_b32 v29, 0xffff0000, v17
  v_lshlrev_b32 v30, 16, v101
  v_and_b32 v31, 0xffff0000, v101
  v_pk_add_f32 v[28:29], v[28:29], v[30:31]
  v_cvt_pk_bf16_f32 v17, v28, v29
  v_lshlrev_b32 v28, 16, v18
  v_and_b32 v29, 0xffff0000, v18
  v_lshlrev_b32 v30, 16, v102
  v_and_b32 v31, 0xffff0000, v102
  v_pk_add_f32 v[28:29], v[28:29], v[30:31]
  v_cvt_pk_bf16_f32 v18, v28, v29
  v_lshlrev_b32 v28, 16, v19
  v_and_b32 v29, 0xffff0000, v19
  v_lshlrev_b32 v30, 16, v103
  v_and_b32 v31, 0xffff0000, v103
  v_pk_add_f32 v[28:29], v[28:29], v[30:31]
  v_cvt_pk_bf16_f32 v19, v28, v29
  buffer_store_dwordx4 v[16:19], v109, s[20:23], 0 offen sc1
  v_mov_b32 v24, 0
  v_mov_b32 v25, 0
  s_nop 0
  v_dot2_f32_bf16 v24, v16, v26, v24
  v_dot2_f32_bf16 v25, v16, v16, v25
  v_dot2_f32_bf16 v24, v17, v26, v24
  v_dot2_f32_bf16 v25, v17, v17, v25
  v_dot2_f32_bf16 v24, v18, v26, v24
  v_dot2_f32_bf16 v25, v18, v18, v25
  v_dot2_f32_bf16 v24, v19, v26, v24
  v_dot2_f32_bf16 v25, v19, v19, v25
  s_nop 2
  v_add_f32_dpp v24, v24, v24 quad_perm:[1,0,3,2] row_mask:0xf bank_mask:0xf
  v_add_f32_dpp v25, v25, v25 quad_perm:[1,0,3,2] row_mask:0xf bank_mask:0xf
  s_nop 0
  v_add_f32_dpp v24, v24, v24 quad_perm:[2,3,0,1] row_mask:0xf bank_mask:0xf
  v_add_f32_dpp v25, v25, v25 quad_perm:[2,3,0,1] row_mask:0xf bank_mask:0xf
  s_nop 0
  v_add_f32_dpp v24, v24, v24 row_half_mirror row_mask:0xf bank_mask:0xf
  v_add_f32_dpp v25, v25, v25 row_half_mirror row_mask:0xf bank_mask:0xf
  s_nop 0
  s_mul_i32 s39, s32, 10
  s_add_u32 s39, s39, s33
  s_mul_i32 s39, s39, 1536
  s_lshl_b32 s40, s36, 7
  s_add_u32 s39, s39, s40
  v_lshrrev_b32 v9, 3, v2
  v_lshlrev_b32 v9, 4, v9
  v_add_u32 v9, s39, v9
  v_mov_b32 v12, v24
  v_mov_b32 v13, v25
  v_mov_b32 v14, 0
  v_mov_b32 v15, 0
  s_mov_b32 exec_lo, 0x1010101
  s_mov_b32 exec_hi, 0x1010101
  buffer_store_dwordx4 v[12:15], v9, s[28:31], 0 offen offset:0 sc1
  s_mov_b64 exec, -1
  s_cmp_ge_u32 s36, 3
  s_cbranch_scc1 Lsdone_79
  v_lshlrev_b32 v28, 16, v20
  v_and_b32 v29, 0xffff0000, v20
  v_lshlrev_b32 v30, 16, v104
  v_and_b32 v31, 0xffff0000, v104
  v_pk_add_f32 v[28:29], v[28:29], v[30:31]
  v_cvt_pk_bf16_f32 v20, v28, v29
  v_lshlrev_b32 v28, 16, v21
  v_and_b32 v29, 0xffff0000, v21
  v_lshlrev_b32 v30, 16, v105
  v_and_b32 v31, 0xffff0000, v105
  v_pk_add_f32 v[28:29], v[28:29], v[30:31]
  v_cvt_pk_bf16_f32 v21, v28, v29
  v_lshlrev_b32 v28, 16, v22
  v_and_b32 v29, 0xffff0000, v22
  v_lshlrev_b32 v30, 16, v106
  v_and_b32 v31, 0xffff0000, v106
  v_pk_add_f32 v[28:29], v[28:29], v[30:31]
  v_cvt_pk_bf16_f32 v22, v28, v29
  v_lshlrev_b32 v28, 16, v23
  v_and_b32 v29, 0xffff0000, v23
  v_lshlrev_b32 v30, 16, v107
  v_and_b32 v31, 0xffff0000, v107
  v_pk_add_f32 v[28:29], v[28:29], v[30:31]
  v_cvt_pk_bf16_f32 v23, v28, v29
  buffer_store_dwordx4 v[20:23], v110, s[20:23], 0 offen sc1
  v_mov_b32 v24, 0
  v_mov_b32 v25, 0
  s_nop 0
  v_dot2_f32_bf16 v24, v20, v26, v24
  v_dot2_f32_bf16 v25, v20, v20, v25
  v_dot2_f32_bf16 v24, v21, v26, v24
  v_dot2_f32_bf16 v25, v21, v21, v25
  v_dot2_f32_bf16 v24, v22, v26, v24
  v_dot2_f32_bf16 v25, v22, v22, v25
  v_dot2_f32_bf16 v24, v23, v26, v24
  v_dot2_f32_bf16 v25, v23, v23, v25
  s_nop 2
  v_add_f32_dpp v24, v24, v24 quad_perm:[1,0,3,2] row_mask:0xf bank_mask:0xf
  v_add_f32_dpp v25, v25, v25 quad_perm:[1,0,3,2] row_mask:0xf bank_mask:0xf
  s_nop 0
  v_add_f32_dpp v24, v24, v24 quad_perm:[2,3,0,1] row_mask:0xf bank_mask:0xf
  v_add_f32_dpp v25, v25, v25 quad_perm:[2,3,0,1] row_mask:0xf bank_mask:0xf
  s_nop 0
  v_add_f32_dpp v24, v24, v24 row_half_mirror row_mask:0xf bank_mask:0xf
  v_add_f32_dpp v25, v25, v25 row_half_mirror row_mask:0xf bank_mask:0xf
  s_nop 0
  s_mul_i32 s39, s32, 10
  s_add_u32 s39, s39, s33
  s_mul_i32 s39, s39, 1536
  s_lshl_b32 s40, s36, 7
  s_add_u32 s39, s39, s40
  v_lshrrev_b32 v9, 3, v2
  v_lshlrev_b32 v9, 4, v9
  v_add_u32 v9, s39, v9
  v_mov_b32 v12, v24
  v_mov_b32 v13, v25
  v_mov_b32 v14, 0
  v_mov_b32 v15, 0
  s_mov_b32 exec_lo, 0x1010101
  s_mov_b32 exec_hi, 0x1010101
  buffer_store_dwordx4 v[12:15], v9, s[28:31], 0 offen offset:1024 sc1
  s_mov_b64 exec, -1
Lsdone_79:
  s_mul_i32 s85, s32, 10
  s_add_u32 s85, s85, s33
  s_lshl_b32 s85, s85, 7
  s_add_u32 s85, s85, 0x10000
  s_waitcnt vmcnt(0)
  s_barrier
Linv_65:
  s_and_b32 s39, s2, 7
  s_lshr_b32 s40, s2, 3
  s_lshl_b32 s39, s39, 5
  s_add_u32 s39, s39, s40
  s_cmp_lt_u32 s39, 243
  s_cselect_b32 s87, 1, 0
  s_cmp_ge_u32 s39, 108
  s_cselect_b32 s40, 108, 0
  s_sub_u32 s41, s39, s40
  s_mul_i32 s33, s41, 16384
  s_lshr_b32 s33, s33, 16
  s_mul_i32 s32, s41, 13108
  s_lshr_b32 s32, s32, 16
  s_cmp_ge_u32 s39, 108
  s_cselect_b32 s33, s32, s33
  s_cselect_b32 s32, 5, 4
  s_mul_i32 s32, s32, s33
  s_sub_u32 s32, s41, s32
  s_cmp_ge_u32 s39, 108
  s_cselect_b32 s40, 4, 0
  s_add_u32 s32, s32, s40
  s_cmp_eq_u32 s87, 0
  s_cbranch_scc1 Linv_81
  s_mul_i32 s34, s32, 228
  s_mul_i32 s35, s33, 64
  s_add_u32 s68, s34, 228
  s_min_u32 s68, s68, 2048
  v_lshrrev_b32 v3, 3, v2
  v_and_b32 v4, 7, v2
  v_lshrrev_b32 v5, 1, v3
  v_xor_b32 v6, v4, v5
  v_lshlrev_b32 v6, 4, v6
  s_lshl_b32 s39, s96, 3
  s_add_u32 s39, s39, s34
  v_add_u32 v7, s39, v3
  s_mov_b32 s39, 1280
  v_mul_lo_u32 v7, v7, s39
  v_add_u32 v7, v7, v6
  s_and_b32 s39, s96, 1
  s_lshl_b32 s39, s39, 6
  v_xor_b32 v7, s39, v7
  v_add_u32 v32, 0, v7
  v_add_u32 v33, 40960, v7
  v_add_u32 v34, 81920, v7
  v_add_u32 v35, 122880, v7
  v_add_u32 v36, 163840, v7
  v_add_u32 v37, 204800, v7
  v_add_u32 v38, 245760, v7
  v_add_u32 v39, 286720, v7
  v_and_b32 v8, 1, v5
  v_lshlrev_b32 v8, 1, v8
  v_xor_b32 v8, v4, v8
  v_lshlrev_b32 v8, 4, v8
  s_lshl_b32 s39, s96, 3
  v_add_u32 v9, s39, v3
  s_mov_b32 s39, 3456
  v_mul_lo_u32 v9, v9, s39
  v_add_u32 v9, v9, v8
  s_and_b32 s39, s96, 1
  s_lshl_b32 s39, s39, 6
  v_xor_b32 v9, s39, v9
  s_lshl_b32 s40, s35, 1
  v_add_u32 v9, s40, v9
  v_add_u32 v40, 0, v9
  v_add_u32 v41, 110592, v9
  v_add_u32 v42, 0, v9
  v_add_u32 v43, 110592, v9
  s_lshl_b32 s86, s96, 10
  s_cmp_eq_u32 s96, 0
  s_cselect_b32 s64, -1, 0
  s_mov_b32 s65, 0
  s_mul_i32 s69, s33, 1
  s_mul_i32 s39, s32, 9
  s_add_u32 s69, s69, s39
  s_lshr_b32 s69, s69, 2
  s_mul_i32 s39, s69, 6554
  s_lshr_b32 s39, s39, 16
  s_mul_i32 s39, s39, 10
  s_sub_u32 s69, s69, s39
  s_mov_b32 s92, s69
  s_mov_b32 s6, 0
  s_mov_b32 s7, 0
  s_add_u32 s8, s62, 0xb00000
  s_addc_u32 s9, s63, 0
  s_and_b32 s9, s9, 0xffff
  s_mov_b32 s10, 0x280000
  s_mov_b32 s11, 0x20000
  s_mov_b32 s12, s52
  s_mov_b32 s13, s53
  s_and_b32 s13, s13, 0xffff
  s_mov_b32 s14, 0x21c000
  s_mov_b32 s15, 0x20000
  s_mov_b32 s16, s54
  s_mov_b32 s17, s55
  s_and_b32 s17, s17, 0xffff
  s_mov_b32 s18, 0x21c000
  s_mov_b32 s19, 0x20000
  s_add_u32 s28, s62, 0x1800000
  s_addc_u32 s29, s63, 0
  s_and_b32 s29, s29, 0xffff
  s_mov_b32 s30, 0x5dc00
  s_mov_b32 s31, 0x20000
  s_add_u32 s20, s62, 0x1000000
  s_addc_u32 s21, s63, 0
  s_and_b32 s21, s21, 0xffff
  s_mov_b32 s22, 0x6c0000
  s_mov_b32 s23, 0x20000
  s_mov_b32 s37, 0
  s_mov_b32 s93, 0
  s_mul_i32 s42, s69, 128
  s_mul_i32 s43, s92, 221184
  s_mov_b32 s38, 3
Lbpre_82:
  s_add_u32 s95, s93, s86
  s_add_u32 m0, s95, 30720
  s_nop 0
  buffer_load_dwordx4 v40, s[12:15], s43 offen lds
  s_add_u32 m0, s95, 34816
  s_nop 0
  buffer_load_dwordx4 v41, s[12:15], s43 offen lds
  s_add_u32 m0, s95, 38912
  s_nop 0
  buffer_load_dwordx4 v42, s[16:19], s43 offen lds
  s_add_u32 m0, s95, 43008
  s_nop 0
  buffer_load_dwordx4 v43, s[16:19], s43 offen lds
  s_add_u32 s92, s92, 1
  s_cmp_ge_u32 s92, 10
  s_cselect_b32 s92, 0, s92
  s_mul_i32 s43, s92, 221184
  s_add_u32 s93, s93, 47104
  s_cmp_ge_u32 s93, 141312
  s_cselect_b32 s93, 0, s93
  s_sub_u32 s38, s38, 1
  s_cmp_lg_u32 s38, 0
  s_cbranch_scc1 Lbpre_82
  s_barrier
  s_add_u32 s94, s37, s86
  s_add_u32 m0, s94, 0
  s_nop 0
  buffer_load_dwordx4 v32, s[8:11], s42 offen sc1 lds
  s_add_u32 m0, s94, 4096
  s_nop 0
  buffer_load_dwordx4 v33, s[8:11], s42 offen sc1 lds
  s_add_u32 m0, s94, 8192
  s_nop 0
  buffer_load_dwordx4 v34, s[8:11], s42 offen sc1 lds
  s_add_u32 m0, s94, 12288
  s_nop 0
  buffer_load_dwordx4 v35, s[8:11], s42 offen sc1 lds
  s_add_u32 m0, s94, 16384
  s_nop 0
  buffer_load_dwordx4 v36, s[8:11], s42 offen sc1 lds
  s_add_u32 m0, s94, 20480
  s_nop 0
  buffer_load_dwordx4 v37, s[8:11], s42 offen sc1 lds
  s_add_u32 m0, s94, 24576
  s_nop 0
  buffer_load_dwordx4 v38, s[8:11], s42 offen sc1 lds
  s_cmp_eq_u64 s[64:65], 0
  s_cbranch_scc1 Lsk_83
  s_add_u32 m0, s94, 28672
  s_mov_b64 exec, s[64:65]
  buffer_load_dwordx4 v39, s[8:11], s42 offen sc1 lds
  s_mov_b64 exec, -1
Lsk_83:
  s_add_u32 s69, s69, 1
  s_cmp_ge_u32 s69, 10
  s_cselect_b32 s69, 0, s69
  s_mul_i32 s42, s69, 128
  s_add_u32 s37, s37, 47104
  s_cmp_ge_u32 s37, 141312
  s_cselect_b32 s37, 0, s37
  s_add_u32 s94, s37, s86
  s_add_u32 m0, s94, 0
  s_nop 0
  buffer_load_dwordx4 v32, s[8:11], s42 offen sc1 lds
  s_add_u32 m0, s94, 4096
  s_nop 0
  buffer_load_dwordx4 v33, s[8:11], s42 offen sc1 lds
  s_add_u32 m0, s94, 8192
  s_nop 0
  buffer_load_dwordx4 v34, s[8:11], s42 offen sc1 lds
  s_add_u32 m0, s94, 12288
  s_nop 0
  buffer_load_dwordx4 v35, s[8:11], s42 offen sc1 lds
  s_add_u32 m0, s94, 16384
  s_nop 0
  buffer_load_dwordx4 v36, s[8:11], s42 offen sc1 lds
  s_add_u32 m0, s94, 20480
  s_nop 0
  buffer_load_dwordx4 v37, s[8:11], s42 offen sc1 lds
  s_add_u32 m0, s94, 24576
  s_nop 0
  buffer_load_dwordx4 v38, s[8:11], s42 offen sc1 lds
  s_cmp_eq_u64 s[64:65], 0
  s_cbranch_scc1 Lsk_84
  s_add_u32 m0, s94, 28672
  s_mov_b64 exec, s[64:65]
  buffer_load_dwordx4 v39, s[8:11], s42 offen sc1 lds
  s_mov_b64 exec, -1
Lsk_84:
  s_add_u32 s69, s69, 1
  s_cmp_ge_u32 s69, 10
  s_cselect_b32 s69, 0, s69
  s_mul_i32 s42, s69, 128
  s_add_u32 s37, s37, 47104
  s_cmp_ge_u32 s37, 141312
  s_cselect_b32 s37, 0, s37
  v_mov_b32 v12, 0
  v_mov_b32 v13, 0
  v_mov_b32 v14, 0
  v_mov_b32 v15, 0
  v_mov_b32 v10, 0x3f803f80
  v_lshlrev_b32 v11, 4, v2
  s_add_u32 s39, s96, 0
  s_cmp_ge_u32 s39, 3
  s_cbranch_scc1 Lpad_85
  s_mul_i32 s39, s39, 47104
  v_add_u32 v16, s39, v11
  ds_write_b128 v16, v[12:15] offset:29184
  v_add_u32 v16, s39, v11
  s_mov_b32 exec_lo, 0xffffff
  s_mov_b32 exec_hi, 0x0
  ds_write_b128 v16, v[12:15] offset:30208
  s_mov_b64 exec, -1
  v_lshlrev_b32 v16, 2, v2
  v_add_u32 v16, s39, v16
  s_mov_b32 exec_lo, 0xffffffff
  s_mov_b32 exec_hi, 0x0
  ds_write_b32 v16, v10 offset:30592
  s_mov_b64 exec, -1
Lpad_85:
  s_mov_b32 s4, s32
  s_mov_b32 s5, s33
  s_and_b32 s39, s2, 7
  s_lshr_b32 s40, s2, 3
  s_lshl_b32 s39, s39, 5
  s_add_u32 s39, s39, s40
  s_cmp_lt_u32 s39, 250
  s_cselect_b32 s87, 1, 0
  s_mul_i32 s40, s39, 525
  s_lshr_b32 s40, s40, 16
  s_mul_i32 s41, s40, 125
  s_sub_u32 s41, s39, s41
  s_mul_i32 s32, s41, 13108
  s_lshr_b32 s32, s32, 16
  s_mul_i32 s33, s32, 5
  s_sub_u32 s33, s41, s33
  s_mul_i32 s40, s40, 5
  s_add_u32 s33, s33, s40
  s_mul_i32 s39, s32, 10923
  s_lshr_b32 s39, s39, 16
  s_mul_i32 s39, s39, 6
  s_sub_u32 s39, s32, s39
  s_mul_i32 s39, s39, 288
  s_lshl_b32 s40, s96, 3
  s_add_u32 s39, s39, s40
  v_lshrrev_b32 v150, 3, v2
  v_add_u32 v150, s39, v150
  s_mov_b32 s40, 1280
  v_mul_lo_u32 v150, v150, s40
  v_and_b32 v151, 7, v2
  v_lshl_add_u32 v150, v151, 4, v150
  s_mul_i32 s40, s33, 128
  v_add_u32 v150, s40, v150
  s_cmp_eq_u32 s87, 0
  s_cselect_b32 s40, 0x80000000, 0
  v_or_b32 v150, s40, v150
  s_mov_b32 s80, s56
  s_mov_b32 s81, s57
  s_and_b32 s81, s81, 0xffff
  s_mov_b32 s82, 0x21c000
  s_mov_b32 s83, 0x20000
  s_mov_b32 s32, s4
  s_mov_b32 s33, s5
  s_waitcnt vmcnt(7)
  s_waitcnt lgkmcnt(0)
  s_barrier
  s_add_u32 s94, s37, s86
  s_add_u32 m0, s94, 0
  s_nop 0
  buffer_load_dwordx4 v32, s[8:11], s42 offen sc1 lds
  s_add_u32 m0, s94, 4096
  s_nop 0
  buffer_load_dwordx4 v33, s[8:11], s42 offen sc1 lds
  s_add_u32 m0, s94, 8192
  s_nop 0
  buffer_load_dwordx4 v34, s[8:11], s42 offen sc1 lds
  s_add_u32 m0, s94, 12288
  s_nop 0
  buffer_load_dwordx4 v35, s[8:11], s42 offen sc1 lds
  s_add_u32 m0, s94, 16384
  s_nop 0
  buffer_load_dwordx4 v36, s[8:11], s42 offen sc1 lds
  s_add_u32 m0, s94, 20480
  s_nop 0
  buffer_load_dwordx4 v37, s[8:11], s42 offen sc1 lds
  s_add_u32 m0, s94, 24576
  s_nop 0
  buffer_load_dwordx4 v38, s[8:11], s42 offen sc1 lds
  s_cmp_eq_u64 s[64:65], 0
  s_cbranch_scc1 Lsk_86
  s_add_u32 m0, s94, 28672
  s_mov_b64 exec, s[64:65]
  buffer_load_dwordx4 v39, s[8:11], s42 offen sc1 lds
  s_mov_b64 exec, -1
Lsk_86:
  s_add_u32 s69, s69, 1
  s_cmp_ge_u32 s69, 10
  s_cselect_b32 s69, 0, s69
  s_mul_i32 s42, s69, 128
  s_add_u32 s37, s37, 47104
  s_cmp_ge_u32 s37, 141312
  s_cselect_b32 s37, 0, s37
  s_waitcnt vmcnt(7)
  s_barrier
  s_add_u32 s94, s37, s86
  s_add_u32 m0, s94, 0
  s_nop 0
  buffer_load_dwordx4 v32, s[8:11], s42 offen sc1 lds
  s_add_u32 m0, s94, 4096
  s_nop 0
  buffer_load_dwordx4 v33, s[8:11], s42 offen sc1 lds
  s_add_u32 m0, s94, 8192
  s_nop 0
  buffer_load_dwordx4 v34, s[8:11], s42 offen sc1 lds
  s_add_u32 m0, s94, 12288
  s_nop 0
  buffer_load_dwordx4 v35, s[8:11], s42 offen sc1 lds
  s_add_u32 m0, s94, 16384
  s_nop 0
  buffer_load_dwordx4 v36, s[8:11], s42 offen sc1 lds
  s_add_u32 m0, s94, 20480
  s_nop 0
  buffer_load_dwordx4 v37, s[8:11], s42 offen sc1 lds
  s_add_u32 m0, s94, 24576
  s_nop 0
  buffer_load_dwordx4 v38, s[8:11], s42 offen sc1 lds
  s_cmp_eq_u64 s[64:65], 0
  s_cbranch_scc1 Lsk_87
  s_add_u32 m0, s94, 28672
  s_mov_b64 exec, s[64:65]
  buffer_load_dwordx4 v39, s[8:11], s42 offen sc1 lds
  s_mov_b64 exec, -1
Lsk_87:
  s_add_u32 s69, s69, 1
  s_cmp_ge_u32 s69, 10
  s_cselect_b32 s69, 0, s69
  s_mul_i32 s42, s69, 128
  s_add_u32 s37, s37, 47104
  s_cmp_ge_u32 s37, 141312
  s_cselect_b32 s37, 0, s37
  s_add_u32 s95, s93, s86
  s_add_u32 m0, s95, 30720
  s_nop 0
  buffer_load_dwordx4 v40, s[12:15], s43 offen lds
  s_add_u32 m0, s95, 34816
  s_nop 0
  buffer_load_dwordx4 v41, s[12:15], s43 offen lds
  s_add_u32 m0, s95, 38912
  s_nop 0
  buffer_load_dwordx4 v42, s[16:19], s43 offen lds
  s_add_u32 m0, s95, 43008
  s_nop 0
  buffer_load_dwordx4 v43, s[16:19], s43 offen lds
  s_add_u32 s92, s92, 1
  s_cmp_ge_u32 s92, 10
  s_cselect_b32 s92, 0, s92
  s_mul_i32 s43, s92, 221184
  s_add_u32 s93, s93, 47104
  s_cmp_ge_u32 s93, 141312
  s_cselect_b32 s93, 0, s93
  s_waitcnt vmcnt(11)
  s_barrier
  s_add_u32 s94, s37, s86
  s_add_u32 m0, s94, 0
  s_nop 0
  buffer_load_dwordx4 v32, s[8:11], s42 offen sc1 lds
  s_add_u32 m0, s94, 4096
  s_nop 0
  buffer_load_dwordx4 v33, s[8:11], s42 offen sc1 lds
  s_add_u32 m0, s94, 8192
  s_nop 0
  buffer_load_dwordx4 v34, s[8:11], s42 offen sc1 lds
  s_add_u32 m0, s94, 12288
  s_nop 0
  buffer_load_dwordx4 v35, s[8:11], s42 offen sc1 lds
  s_add_u32 m0, s94, 16384
  s_nop 0
  buffer_load_dwordx4 v36, s[8:11], s42 offen sc1 lds
  s_add_u32 m0, s94, 20480
  s_nop 0
  buffer_load_dwordx4 v37, s[8:11], s42 offen sc1 lds
  s_add_u32 m0, s94, 24576
  s_nop 0
  buffer_load_dwordx4 v38, s[8:11], s42 offen sc1 lds
  s_cmp_eq_u64 s[64:65], 0
  s_cbranch_scc1 Lsk_88
  s_add_u32 m0, s94, 28672
  s_mov_b64 exec, s[64:65]
  buffer_load_dwordx4 v39, s[8:11], s42 offen sc1 lds
  s_mov_b64 exec, -1
Lsk_88:
  s_add_u32 s69, s69, 1
  s_cmp_ge_u32 s69, 10
  s_cselect_b32 s69, 0, s69
  s_mul_i32 s42, s69, 128
  s_add_u32 s37, s37, 47104
  s_cmp_ge_u32 s37, 141312
  s_cselect_b32 s37, 0, s37
  s_add_u32 s95, s93, s86
  s_add_u32 m0, s95, 30720
  s_nop 0
  buffer_load_dwordx4 v40, s[12:15], s43 offen lds
  s_add_u32 m0, s95, 34816
  s_nop 0
  buffer_load_dwordx4 v41, s[12:15], s43 offen lds
  s_add_u32 m0, s95, 38912
  s_nop 0
  buffer_load_dwordx4 v42, s[16:19], s43 offen lds
  s_add_u32 m0, s95, 43008
  s_nop 0
  buffer_load_dwordx4 v43, s[16:19], s43 offen lds
  s_add_u32 s92, s92, 1
  s_cmp_ge_u32 s92, 10
  s_cselect_b32 s92, 0, s92
  s_mul_i32 s43, s92, 221184
  s_add_u32 s93, s93, 47104
  s_cmp_ge_u32 s93, 141312
  s_cselect_b32 s93, 0, s93
  s_waitcnt vmcnt(11)
  s_barrier
  s_add_u32 s94, s37, s86
  s_add_u32 m0, s94, 0
  s_nop 0
  buffer_load_dwordx4 v32, s[8:11], s42 offen sc1 lds
  s_add_u32 m0, s94, 4096
  s_nop 0
  buffer_load_dwordx4 v33, s[8:11], s42 offen sc1 lds
  s_add_u32 m0, s94, 8192
  s_nop 0
  buffer_load_dwordx4 v34, s[8:11], s42 offen sc1 lds
  s_add_u32 m0, s94, 12288
  s_nop 0
  buffer_load_dwordx4 v35, s[8:11], s42 offen sc1 lds
  s_add_u32 m0, s94, 16384
  s_nop 0
  buffer_load_dwordx4 v36, s[8:11], s42 offen sc1 lds
  s_add_u32 m0, s94, 20480
  s_nop 0
  buffer_load_dwordx4 v37, s[8:11], s42 offen sc1 lds
  s_add_u32 m0, s94, 24576
  s_nop 0
  buffer_load_dwordx4 v38, s[8:11], s42 offen sc1 lds
  s_cmp_eq_u64 s[64:65], 0
  s_cbranch_scc1 Lsk_89
  s_add_u32 m0, s94, 28672
  s_mov_b64 exec, s[64:65]
  buffer_load_dwordx4 v39, s[8:11], s42 offen sc1 lds
  s_mov_b64 exec, -1
Lsk_89:
  s_add_u32 s69, s69, 1
  s_cmp_ge_u32 s69, 10
  s_cselect_b32 s69, 0, s69
  s_mul_i32 s42, s69, 128
  s_add_u32 s37, s37, 47104
  s_cmp_ge_u32 s37, 141312
  s_cselect_b32 s37, 0, s37
  s_add_u32 s95, s93, s86
  s_add_u32 m0, s95, 30720
  s_nop 0
  buffer_load_dwordx4 v40, s[12:15], s43 offen lds
  s_add_u32 m0, s95, 34816
  s_nop 0
  buffer_load_dwordx4 v41, s[12:15], s43 offen lds
  s_add_u32 m0, s95, 38912
  s_nop 0
  buffer_load_dwordx4 v42, s[16:19], s43 offen lds
  s_add_u32 m0, s95, 43008
  s_nop 0
  buffer_load_dwordx4 v43, s[16:19], s43 offen lds
  s_add_u32 s92, s92, 1
  s_cmp_ge_u32 s92, 10
  s_cselect_b32 s92, 0, s92
  s_mul_i32 s43, s92, 221184
  s_add_u32 s93, s93, 47104
  s_cmp_ge_u32 s93, 141312
  s_cselect_b32 s93, 0, s93
  s_waitcnt vmcnt(11)
  s_barrier
  s_add_u32 s94, s37, s86
  s_add_u32 m0, s94, 0
  s_nop 0
  buffer_load_dwordx4 v32, s[8:11], s42 offen sc1 lds
  s_add_u32 m0, s94, 4096
  s_nop 0
  buffer_load_dwordx4 v33, s[8:11], s42 offen sc1 lds
  s_add_u32 m0, s94, 8192
  s_nop 0
  buffer_load_dwordx4 v34, s[8:11], s42 offen sc1 lds
  s_add_u32 m0, s94, 12288
  s_nop 0
  buffer_load_dwordx4 v35, s[8:11], s42 offen sc1 lds
  s_add_u32 m0, s94, 16384
  s_nop 0
  buffer_load_dwordx4 v36, s[8:11], s42 offen sc1 lds
  s_add_u32 m0, s94, 20480
  s_nop 0
  buffer_load_dwordx4 v37, s[8:11], s42 offen sc1 lds
  s_add_u32 m0, s94, 24576
  s_nop 0
  buffer_load_dwordx4 v38, s[8:11], s42 offen sc1 lds
  s_cmp_eq_u64 s[64:65], 0
  s_cbranch_scc1 Lsk_90
  s_add_u32 m0, s94, 28672
  s_mov_b64 exec, s[64:65]
  buffer_load_dwordx4 v39, s[8:11], s42 offen sc1 lds
  s_mov_b64 exec, -1
Lsk_90:
  s_add_u32 s69, s69, 1
  s_cmp_ge_u32 s69, 10
  s_cselect_b32 s69, 0, s69
  s_mul_i32 s42, s69, 128
  s_add_u32 s37, s37, 47104
  s_cmp_ge_u32 s37, 141312
  s_cselect_b32 s37, 0, s37
  s_add_u32 s95, s93, s86
  s_add_u32 m0, s95, 30720
  s_nop 0
  buffer_load_dwordx4 v40, s[12:15], s43 offen lds
  s_add_u32 m0, s95, 34816
  s_nop 0
  buffer_load_dwordx4 v41, s[12:15], s43 offen lds
  s_add_u32 m0, s95, 38912
  s_nop 0
  buffer_load_dwordx4 v42, s[16:19], s43 offen lds
  s_add_u32 m0, s95, 43008
  s_nop 0
  buffer_load_dwordx4 v43, s[16:19], s43 offen lds
  s_add_u32 s92, s92, 1
  s_cmp_ge_u32 s92, 10
  s_cselect_b32 s92, 0, s92
  s_mul_i32 s43, s92, 221184
  s_add_u32 s93, s93, 47104
  s_cmp_ge_u32 s93, 141312
  s_cselect_b32 s93, 0, s93
  s_waitcnt vmcnt(11)
  s_barrier
  s_add_u32 s94, s37, s86
  s_add_u32 m0, s94, 0
  s_nop 0
  buffer_load_dwordx4 v32, s[8:11], s42 offen sc1 lds
  s_add_u32 m0, s94, 4096
  s_nop 0
  buffer_load_dwordx4 v33, s[8:11], s42 offen sc1 lds
  s_add_u32 m0, s94, 8192
  s_nop 0
  buffer_load_dwordx4 v34, s[8:11], s42 offen sc1 lds
  s_add_u32 m0, s94, 12288
  s_nop 0
  buffer_load_dwordx4 v35, s[8:11], s42 offen sc1 lds
  s_add_u32 m0, s94, 16384
  s_nop 0
  buffer_load_dwordx4 v36, s[8:11], s42 offen sc1 lds
  s_add_u32 m0, s94, 20480
  s_nop 0
  buffer_load_dwordx4 v37, s[8:11], s42 offen sc1 lds
  s_add_u32 m0, s94, 24576
  s_nop 0
  buffer_load_dwordx4 v38, s[8:11], s42 offen sc1 lds
  s_cmp_eq_u64 s[64:65], 0
  s_cbranch_scc1 Lsk_91
  s_add_u32 m0, s94, 28672
  s_mov_b64 exec, s[64:65]
  buffer_load_dwordx4 v39, s[8:11], s42 offen sc1 lds
  s_mov_b64 exec, -1
Lsk_91:
  s_add_u32 s69, s69, 1
  s_cmp_ge_u32 s69, 10
  s_cselect_b32 s69, 0, s69
  s_mul_i32 s42, s69, 128
  s_add_u32 s37, s37, 47104
  s_cmp_ge_u32 s37, 141312
  s_cselect_b32 s37, 0, s37
  s_add_u32 s95, s93, s86
  s_add_u32 m0, s95, 30720
  s_nop 0
  buffer_load_dwordx4 v40, s[12:15], s43 offen lds
  s_add_u32 m0, s95, 34816
  s_nop 0
  buffer_load_dwordx4 v41, s[12:15], s43 offen lds
  s_add_u32 m0, s95, 38912
  s_nop 0
  buffer_load_dwordx4 v42, s[16:19], s43 offen lds
  s_add_u32 m0, s95, 43008
  s_nop 0
  buffer_load_dwordx4 v43, s[16:19], s43 offen lds
  s_add_u32 s92, s92, 1
  s_cmp_ge_u32 s92, 10
  s_cselect_b32 s92, 0, s92
  s_mul_i32 s43, s92, 221184
  s_add_u32 s93, s93, 47104
  s_cmp_ge_u32 s93, 141312
  s_cselect_b32 s93, 0, s93
  s_waitcnt vmcnt(11)
  s_barrier
  s_add_u32 s94, s37, s86
  s_add_u32 m0, s94, 0
  s_nop 0
  buffer_load_dwordx4 v32, s[8:11], s42 offen sc1 lds
  s_add_u32 m0, s94, 4096
  s_nop 0
  buffer_load_dwordx4 v33, s[8:11], s42 offen sc1 lds
  s_add_u32 m0, s94, 8192
  s_nop 0
  buffer_load_dwordx4 v34, s[8:11], s42 offen sc1 lds
  s_add_u32 m0, s94, 12288
  s_nop 0
  buffer_load_dwordx4 v35, s[8:11], s42 offen sc1 lds
  s_add_u32 m0, s94, 16384
  s_nop 0
  buffer_load_dwordx4 v36, s[8:11], s42 offen sc1 lds
  s_add_u32 m0, s94, 20480
  s_nop 0
  buffer_load_dwordx4 v37, s[8:11], s42 offen sc1 lds
  s_add_u32 m0, s94, 24576
  s_nop 0
  buffer_load_dwordx4 v38, s[8:11], s42 offen sc1 lds
  s_cmp_eq_u64 s[64:65], 0
  s_cbranch_scc1 Lsk_92
  s_add_u32 m0, s94, 28672
  s_mov_b64 exec, s[64:65]
  buffer_load_dwordx4 v39, s[8:11], s42 offen sc1 lds
  s_mov_b64 exec, -1
Lsk_92:
  s_add_u32 s69, s69, 1
  s_cmp_ge_u32 s69, 10
  s_cselect_b32 s69, 0, s69
  s_mul_i32 s42, s69, 128
  s_add_u32 s37, s37, 47104
  s_cmp_ge_u32 s37, 141312
  s_cselect_b32 s37, 0, s37
  s_add_u32 s95, s93, s86
  s_add_u32 m0, s95, 30720
  s_nop 0
  buffer_load_dwordx4 v40, s[12:15], s43 offen lds
  s_add_u32 m0, s95, 34816
  s_nop 0
  buffer_load_dwordx4 v41, s[12:15], s43 offen lds
  s_add_u32 m0, s95, 38912
  s_nop 0
  buffer_load_dwordx4 v42, s[16:19], s43 offen lds
  s_add_u32 m0, s95, 43008
  s_nop 0
  buffer_load_dwordx4 v43, s[16:19], s43 offen lds
  s_add_u32 s92, s92, 1
  s_cmp_ge_u32 s92, 10
  s_cselect_b32 s92, 0, s92
  s_mul_i32 s43, s92, 221184
  s_add_u32 s93, s93, 47104
  s_cmp_ge_u32 s93, 141312
  s_cselect_b32 s93, 0, s93
  buffer_load_dwordx4 v[152:155], v150, s[80:83], 0 offen
  v_add_u32 v150, 40960, v150
  buffer_load_dwordx4 v[152:155], v150, s[80:83], 0 offen
  v_add_u32 v150, 40960, v150
  buffer_load_dwordx4 v[152:155], v150, s[80:83], 0 offen
  v_add_u32 v150, 40960, v150
  buffer_load_dwordx4 v[152:155], v150, s[80:83], 0 offen
  v_add_u32 v150, 40960, v150
  buffer_load_dwordx4 v[152:155], v150, s[80:83], 0 offen
  v_add_u32 v150, 40960, v150
  s_waitcnt vmcnt(16)
  s_barrier
  s_add_u32 s94, s37, s86
  s_add_u32 m0, s94, 0
  s_nop 0
  buffer_load_dwordx4 v32, s[8:11], s42 offen sc1 lds
  s_add_u32 m0, s94, 4096
  s_nop 0
  buffer_load_dwordx4 v33, s[8:11], s42 offen sc1 lds
  s_add_u32 m0, s94, 8192
  s_nop 0
  buffer_load_dwordx4 v34, s[8:11], s42 offen sc1 lds
  s_add_u32 m0, s94, 12288
  s_nop 0
  buffer_load_dwordx4 v35, s[8:11], s42 offen sc1 lds
  s_add_u32 m0, s94, 16384
  s_nop 0
  buffer_load_dwordx4 v36, s[8:11], s42 offen sc1 lds
  s_add_u32 m0, s94, 20480
  s_nop 0
  buffer_load_dwordx4 v37, s[8:11], s42 offen sc1 lds
  s_add_u32 m0, s94, 24576
  s_nop 0
  buffer_load_dwordx4 v38, s[8:11], s42 offen sc1 lds
  s_cmp_eq_u64 s[64:65], 0
  s_cbranch_scc1 Lsk_93
  s_add_u32 m0, s94, 28672
  s_mov_b64 exec, s[64:65]
  buffer_load_dwordx4 v39, s[8:11], s42 offen sc1 lds
  s_mov_b64 exec, -1
Lsk_93:
  s_add_u32 s69, s69, 1
  s_cmp_ge_u32 s69, 10
  s_cselect_b32 s69, 0, s69
  s_mul_i32 s42, s69, 128
  s_add_u32 s37, s37, 47104
  s_cmp_ge_u32 s37, 141312
  s_cselect_b32 s37, 0, s37
  s_add_u32 s95, s93, s86
  s_add_u32 m0, s95, 30720
  s_nop 0
  buffer_load_dwordx4 v40, s[12:15], s43 offen lds
  s_add_u32 m0, s95, 34816
  s_nop 0
  buffer_load_dwordx4 v41, s[12:15], s43 offen lds
  s_add_u32 m0, s95, 38912
  s_nop 0
  buffer_load_dwordx4 v42, s[16:19], s43 offen lds
  s_add_u32 m0, s95, 43008
  s_nop 0
  buffer_load_dwordx4 v43, s[16:19], s43 offen lds
  s_add_u32 s92, s92, 1
  s_cmp_ge_u32 s92, 10
  s_cselect_b32 s92, 0, s92
  s_mul_i32 s43, s92, 221184
  s_add_u32 s93, s93, 47104
  s_cmp_ge_u32 s93, 141312
  s_cselect_b32 s93, 0, s93
  buffer_load_dwordx4 v[152:155], v150, s[80:83], 0 offen
  v_add_u32 v150, 40960, v150
  buffer_load_dwordx4 v[152:155], v150, s[80:83], 0 offen
  v_add_u32 v150, 40960, v150
  buffer_load_dwordx4 v[152:155], v150, s[80:83], 0 offen
  v_add_u32 v150, 40960, v150
  buffer_load_dwordx4 v[152:155], v150, s[80:83], 0 offen
  s_waitcnt vmcnt(20)
  s_barrier
  s_lshl_b32 s39, s96, 6
  v_add_u32 v12, s39, v2
  v_add_u32 v13, s34, v12
  v_mul_u32_u24 v15, 1599, v13
  v_lshrrev_b32 v15, 17, v15
  v_mul_u32_u24 v16, 82, v15
  v_sub_u32 v16, v13, v16
  v_mul_u32_u24 v15, 15360, v15
  v_lshl_add_u32 v13, v16, 4, v15
  v_add_u32 v15, s34, v12
  v_cmp_gt_u32 vcc, s68, v15
  v_mov_b32 v14, 0x80000000
  s_nop 0
  v_cndmask_b32 v13, v14, v13, vcc
  s_mov_b32 s39, 0
  buffer_load_dwordx2 v[64:65], v13, s[28:31], s39 offen sc1
  s_mov_b32 s39, 1536
  buffer_load_dwordx2 v[66:67], v13, s[28:31], s39 offen sc1
  s_mov_b32 s39, 3072
  buffer_load_dwordx2 v[68:69], v13, s[28:31], s39 offen sc1
  s_mov_b32 s39, 4608
  buffer_load_dwordx2 v[70:71], v13, s[28:31], s39 offen sc1
  s_mov_b32 s39, 6144
  buffer_load_dwordx2 v[72:73], v13, s[28:31], s39 offen sc1
  s_mov_b32 s39, 7680
  buffer_load_dwordx2 v[74:75], v13, s[28:31], s39 offen sc1
  s_mov_b32 s39, 9216
  buffer_load_dwordx2 v[76:77], v13, s[28:31], s39 offen sc1
  s_mov_b32 s39, 10752
  buffer_load_dwordx2 v[78:79], v13, s[28:31], s39 offen sc1
  s_mov_b32 s39, 12288
  buffer_load_dwordx2 v[80:81], v13, s[28:31], s39 offen sc1
  s_mov_b32 s39, 13824
  buffer_load_dwordx2 v[82:83], v13, s[28:31], s39 offen sc1
  s_waitcnt vmcnt(14)
  s_barrier
  s_waitcnt vmcnt(0)
  v_pk_add_f32 v[64:65], v[64:65], v[66:67]
  v_pk_add_f32 v[64:65], v[64:65], v[68:69]
  v_pk_add_f32 v[64:65], v[64:65], v[70:71]
  v_pk_add_f32 v[64:65], v[64:65], v[72:73]
  v_pk_add_f32 v[64:65], v[64:65], v[74:75]
  v_pk_add_f32 v[64:65], v[64:65], v[76:77]
  v_pk_add_f32 v[64:65], v[64:65], v[78:79]
  v_pk_add_f32 v[64:65], v[64:65], v[80:81]
  v_pk_add_f32 v[64:65], v[64:65], v[82:83]
  v_mul_f32 v64, 0x3acccccd, v64
  v_mul_f32 v65, 0x3acccccd, v65
  v_fma_f32 v65, -v64, v64, v65
  v_add_f32 v65, 0x3727c5ac, v65
  v_rsq_f32 v65, v65
  v_lshlrev_b32 v12, 3, v12
  v_add_u32 v12, 141312, v12
  s_cmp_eq_u32 s96, 3
  s_cselect_b32 exec_hi, 0xffff, -1
  ds_write_b64 v12, v[64:65]
  s_mov_b64 exec, -1
  v_lshrrev_b32 v3, 3, v2
  v_and_b32 v4, 7, v2
  v_xor_b32 v5, v4, v3
  v_lshlrev_b32 v5, 4, v5
  v_lshl_add_u32 v50, v3, 7, v5
  s_lshl_b32 s39, s96, 10
  s_add_u32 s39, s39, 47104
  v_add_u32 v50, s39, v50
  s_lshl_b32 s39, s96, 3
  s_add_u32 s39, s39, s34
  v_add_u32 v51, s39, v3
  s_mov_b32 s40, 3456
  v_mul_lo_u32 v52, v51, s40
  s_lshl_b32 s39, s35, 1
  v_lshl_add_u32 v52, v4, 4, v52
  v_add_u32 v52, s39, v52
  s_waitcnt lgkmcnt(0)
  s_barrier
  s_barrier
  ds_read_b128 v[56:59], v50 offset:0
  ds_read_b128 v[60:63], v50 offset:4096
  ds_read_b128 v[64:67], v50 offset:16384
  ds_read_b128 v[68:71], v50 offset:20480
  v_add_u32 v54, 0, v52
  s_waitcnt lgkmcnt(3)
  buffer_store_dwordx4 v[56:59], v54, s[20:23], 0 offen sc1
  v_add_u32 v53, 110592, v52
  s_waitcnt lgkmcnt(2)
  buffer_store_dwordx4 v[60:63], v53, s[20:23], 0 offen sc1
  v_add_u32 v54, 442368, v52
  s_waitcnt lgkmcnt(1)
  buffer_store_dwordx4 v[64:67], v54, s[20:23], 0 offen sc1
  v_add_u32 v53, 552960, v52
  s_waitcnt lgkmcnt(0)
  buffer_store_dwordx4 v[68:71], v53, s[20:23], 0 offen sc1
  s_barrier
  ds_read_b128 v[56:59], v50 offset:8192
  ds_read_b128 v[60:63], v50 offset:12288
  ds_read_b128 v[64:67], v50 offset:24576
  ds_read_b128 v[68:71], v50 offset:28672
  v_add_u32 v54, 221184, v52
  s_waitcnt lgkmcnt(3)
  buffer_store_dwordx4 v[56:59], v54, s[20:23], 0 offen sc1
  v_add_u32 v53, 331776, v52
  s_waitcnt lgkmcnt(2)
  buffer_store_dwordx4 v[60:63], v53, s[20:23], 0 offen sc1
  v_add_u32 v54, 663552, v52
  s_waitcnt lgkmcnt(1)
  buffer_store_dwordx4 v[64:67], v54, s[20:23], 0 offen sc1
  v_add_u32 v53, 774144, v52
  v_add_u32 v55, 224, v51
  s_add_u32 s39, s34, 228
  v_cmp_gt_u32 vcc, s39, v55
  s_and_saveexec_b64 s[80:81], vcc
  s_waitcnt lgkmcnt(0)
  buffer_store_dwordx4 v[68:71], v53, s[20:23], 0 offen sc1
  s_mov_b64 exec, s[80:81]
  s_mul_i32 s85, s32, 27
  s_add_u32 s85, s85, s33
  s_lshl_b32 s85, s85, 7
  s_add_u32 s85, s85, 0x18000
  s_waitcnt vmcnt(0)
  s_barrier
Linv_81:
  s_and_b32 s39, s2, 7
  s_lshr_b32 s40, s2, 3
  s_lshl_b32 s39, s39, 5
  s_add_u32 s39, s39, s40
  s_cmp_lt_u32 s39, 250
  s_cselect_b32 s87, 1, 0
  s_mul_i32 s40, s39, 525
  s_lshr_b32 s40, s40, 16
  s_mul_i32 s41, s40, 125
  s_sub_u32 s41, s39, s41
  s_mul_i32 s32, s41, 13108
  s_lshr_b32 s32, s32, 16
  s_mul_i32 s33, s32, 5
  s_sub_u32 s33, s41, s33
  s_mul_i32 s40, s40, 5
  s_add_u32 s33, s33, s40
  s_cmp_eq_u32 s87, 0
  s_cbranch_scc1 Linv_95
  s_mul_i32 s34, s32, 82
  s_mul_i32 s35, s33, 64
  s_add_u32 s68, s34, 82
  s_min_u32 s68, s68, 2048
  v_lshrrev_b32 v3, 3, v2
  v_and_b32 v4, 7, v2
  v_lshrrev_b32 v5, 1, v3
  v_xor_b32 v6, v4, v5
  v_lshlrev_b32 v6, 4, v6
  s_lshl_b32 s39, s96, 3
  s_add_u32 s39, s39, s34
  v_add_u32 v7, s39, v3
  s_mov_b32 s39, 3456
  v_mul_lo_u32 v7, v7, s39
  v_add_u32 v7, v7, v6
  s_and_b32 s39, s96, 1
  s_lshl_b32 s39, s39, 6
  v_xor_b32 v7, s39, v7
  v_add_u32 v32, 0, v7
  v_add_u32 v33, 110592, v7
  v_add_u32 v34, 221184, v7
  v_and_b32 v8, 1, v5
  v_lshlrev_b32 v8, 1, v8
  v_xor_b32 v8, v4, v8
  v_lshlrev_b32 v8, 4, v8
  s_lshl_b32 s39, s96, 3
  v_add_u32 v9, s39, v3
  s_mov_b32 s39, 1280
  v_mul_lo_u32 v9, v9, s39
  v_add_u32 v9, v9, v8
  s_and_b32 s39, s96, 1
  s_lshl_b32 s39, s39, 6
  v_xor_b32 v9, s39, v9
  s_lshl_b32 s40, s35, 1
  v_add_u32 v9, s40, v9
  v_add_u32 v35, 0, v9
  v_add_u32 v36, 40960, v9
  s_lshl_b32 s86, s96, 10
  s_cmp_lt_u32 s96, 2
  s_cselect_b32 s64, -1, 0xffff
  s_cselect_b32 s65, -1, 0
  s_cmp_eq_u32 s96, 3
  s_cselect_b32 s64, 0, s64
  s_mul_i32 s69, s33, 2
  s_mul_i32 s39, s32, 17
  s_add_u32 s69, s69, s39
  s_lshr_b32 s69, s69, 2
  s_mul_i32 s39, s69, 2428
  s_lshr_b32 s39, s39, 16
  s_mul_i32 s39, s39, 27
  s_sub_u32 s69, s69, s39
  s_mov_b32 s92, s69
  s_mov_b32 s6, 0
  s_mov_b32 s7, 0
  s_add_u32 s8, s62, 0x1000000
  s_addc_u32 s9, s63, 0
  s_and_b32 s9, s9, 0xffff
  s_mov_b32 s10, 0x6c0000
  s_mov_b32 s11, 0x20000
  s_mov_b32 s12, s56
  s_mov_b32 s13, s57
  s_and_b32 s13, s13, 0xffff
  s_mov_b32 s14, 0x21c000
  s_mov_b32 s15, 0x20000
  s_mov_b32 s20, s58
  s_mov_b32 s21, s59
  s_and_b32 s21, s21, 0xffff
  s_mov_b32 s22, 0x280000
  s_mov_b32 s23, 0x20000
  s_add_u32 s24, s62, 0xb00000
  s_addc_u32 s25, s63, 0
  s_and_b32 s25, s25, 0xffff
  s_mov_b32 s26, 0x280000
  s_mov_b32 s27, 0x20000
  s_mov_b32 s37, 0
  s_mov_b32 s93, 0
  s_mul_i32 s42, s69, 128
  s_mul_i32 s43, s92, 81920
  s_mov_b32 s38, 12
Lbpre_96:
  s_add_u32 s95, s93, s86
  s_add_u32 m0, s95, 61440
  s_nop 0
  buffer_load_dwordx4 v35, s[12:15], s43 offen lds
  s_add_u32 m0, s95, 65536
  s_nop 0
  buffer_load_dwordx4 v36, s[12:15], s43 offen lds
  s_add_u32 s92, s92, 1
  s_cmp_ge_u32 s92, 27
  s_cselect_b32 s92, 0, s92
  s_mul_i32 s43, s92, 81920
  s_add_u32 s93, s93, 8192
  s_cmp_ge_u32 s93, 98304
  s_cselect_b32 s93, 0, s93
  s_sub_u32 s38, s38, 1
  s_cmp_lg_u32 s38, 0
  s_cbranch_scc1 Lbpre_96
  s_barrier
  s_add_u32 s94, s37, s86
  s_add_u32 m0, s94, 0
  s_nop 0
  buffer_load_dwordx4 v32, s[8:11], s42 offen sc1 lds
  s_add_u32 m0, s94, 4096
  s_nop 0
  buffer_load_dwordx4 v33, s[8:11], s42 offen sc1 lds
  s_cmp_eq_u64 s[64:65], 0
  s_cbranch_scc1 Lsk_97
  s_add_u32 m0, s94, 8192
  s_mov_b64 exec, s[64:65]
  buffer_load_dwordx4 v34, s[8:11], s42 offen sc1 lds
  s_mov_b64 exec, -1
Lsk_97:
  s_add_u32 s69, s69, 1
  s_cmp_ge_u32 s69, 27
  s_cselect_b32 s69, 0, s69
  s_mul_i32 s42, s69, 128
  s_add_u32 s37, s37, 12288
  s_cmp_ge_u32 s37, 61440
  s_cselect_b32 s37, 0, s37
  s_add_u32 s94, s37, s86
  s_add_u32 m0, s94, 0
  s_nop 0
  buffer_load_dwordx4 v32, s[8:11], s42 offen sc1 lds
  s_add_u32 m0, s94, 4096
  s_nop 0
  buffer_load_dwordx4 v33, s[8:11], s42 offen sc1 lds
  s_cmp_eq_u64 s[64:65], 0
  s_cbranch_scc1 Lsk_98
  s_add_u32 m0, s94, 8192
  s_mov_b64 exec, s[64:65]
  buffer_load_dwordx4 v34, s[8:11], s42 offen sc1 lds
  s_mov_b64 exec, -1
Lsk_98:
  s_add_u32 s69, s69, 1
  s_cmp_ge_u32 s69, 27
  s_cselect_b32 s69, 0, s69
  s_mul_i32 s42, s69, 128
  s_add_u32 s37, s37, 12288
  s_cmp_ge_u32 s37, 61440
  s_cselect_b32 s37, 0, s37
  v_mov_b32 v12, 0
  v_mov_b32 v13, 0
  v_mov_b32 v14, 0
  v_mov_b32 v15, 0
  v_mov_b32 v10, 0x3f803f80
  v_lshlrev_b32 v11, 4, v2
  s_add_u32 s39, s96, 0
  s_cmp_ge_u32 s39, 5
  s_cbranch_scc1 Lpad_99
  s_mul_i32 s39, s39, 12288
  v_add_u32 v16, s39, v11
  ds_write_b128 v16, v[12:15] offset:10496
  v_add_u32 v16, s39, v11
  s_mov_b32 exec_lo, 0xffffffff
  s_mov_b32 exec_hi, 0xffff
  ds_write_b128 v16, v[12:15] offset:11520
  s_mov_b64 exec, -1
Lpad_99:
  s_add_u32 s39, s96, 4
  s_cmp_ge_u32 s39, 5
  s_cbranch_scc1 Lpad_100
  s_mul_i32 s39, s39, 12288
  v_add_u32 v16, s39, v11
  ds_write_b128 v16, v[12:15] offset:10496
  v_add_u32 v16, s39, v11
  s_mov_b32 exec_lo, 0xffffffff
  s_mov_b32 exec_hi, 0xffff
  ds_write_b128 v16, v[12:15] offset:11520
  s_mov_b64 exec, -1
Lpad_100:
  v_lshrrev_b32 v112, 3, v2
  v_and_b32 v113, 7, v2
  v_xor_b32 v108, v113, v112
  v_lshlrev_b32 v108, 4, v108
  v_lshl_add_u32 v108, v112, 7, v108
  s_lshl_b32 s39, s36, 10
  s_add_u32 s39, s39, 0
  v_add_u32 v108, s39, v108
  s_lshl_b32 s39, s36, 3
  s_add_u32 s39, s39, s34
  v_add_u32 v111, s39, v112
  v_mul_u32_u24 v109, 1280, v111
  s_lshl_b32 s39, s35, 1
  v_lshl_add_u32 v109, v113, 4, v109
  v_add_u32 v109, s39, v109
  v_add_u32 v110, 81920, v109
  v_mov_b32 v114, 0x80000000
  v_cmp_gt_u32 vcc, s68, v111
  v_add_u32 v115, 64, v111
  s_nop 0
  v_cndmask_b32 v109, v114, v109, vcc
  v_cmp_gt_u32 vcc, s68, v115
  s_nop 1
  v_cndmask_b32 v110, v114, v110, vcc
  buffer_load_dwordx4 v[100:103], v109, s[24:27], 0 offen sc1
  buffer_load_dwordx4 v[104:107], v110, s[24:27], 0 offen sc1
  s_waitcnt vmcnt(4)
  s_waitcnt lgkmcnt(0)
  s_barrier
  s_add_u32 s94, s37, s86
  s_add_u32 m0, s94, 0
  s_nop 0
  buffer_load_dwordx4 v32, s[8:11], s42 offen sc1 lds
  s_add_u32 m0, s94, 4096
  s_nop 0
  buffer_load_dwordx4 v33, s[8:11], s42 offen sc1 lds
  s_cmp_eq_u64 s[64:65], 0
  s_cbranch_scc1 Lsk_101
  s_add_u32 m0, s94, 8192
  s_mov_b64 exec, s[64:65]
  buffer_load_dwordx4 v34, s[8:11], s42 offen sc1 lds
  s_mov_b64 exec, -1
Lsk_101:
  s_add_u32 s69, s69, 1
  s_cmp_ge_u32 s69, 27
  s_cselect_b32 s69, 0, s69
  s_mul_i32 s42, s69, 128
  s_add_u32 s37, s37, 12288
  s_cmp_ge_u32 s37, 61440
  s_cselect_b32 s37, 0, s37
  s_add_u32 s94, s37, s86
  s_add_u32 m0, s94, 0
  s_nop 0
  buffer_load_dwordx4 v32, s[8:11], s42 offen sc1 lds
  s_add_u32 m0, s94, 4096
  s_nop 0
  buffer_load_dwordx4 v33, s[8:11], s42 offen sc1 lds
  s_cmp_eq_u64 s[64:65], 0
  s_cbranch_scc1 Lsk_102
  s_add_u32 m0, s94, 8192
  s_mov_b64 exec, s[64:65]
  buffer_load_dwordx4 v34, s[8:11], s42 offen sc1 lds
  s_mov_b64 exec, -1
Lsk_102:
  s_add_u32 s69, s69, 1
  s_cmp_ge_u32 s69, 27
  s_cselect_b32 s69, 0, s69
  s_mul_i32 s42, s69, 128
  s_add_u32 s37, s37, 12288
  s_cmp_ge_u32 s37, 61440
  s_cselect_b32 s37, 0, s37
  s_waitcnt vmcnt(6)
  s_barrier
  s_add_u32 s94, s37, s86
  s_add_u32 m0, s94, 0
  s_nop 0
  buffer_load_dwordx4 v32, s[8:11], s42 offen sc1 lds
  s_add_u32 m0, s94, 4096
  s_nop 0
  buffer_load_dwordx4 v33, s[8:11], s42 offen sc1 lds
  s_cmp_eq_u64 s[64:65], 0
  s_cbranch_scc1 Lsk_103
  s_add_u32 m0, s94, 8192
  s_mov_b64 exec, s[64:65]
  buffer_load_dwordx4 v34, s[8:11], s42 offen sc1 lds
  s_mov_b64 exec, -1
Lsk_103:
  s_add_u32 s69, s69, 1
  s_cmp_ge_u32 s69, 27
  s_cselect_b32 s69, 0, s69
  s_mul_i32 s42, s69, 128
  s_add_u32 s37, s37, 12288
  s_cmp_ge_u32 s37, 61440
  s_cselect_b32 s37, 0, s37
  s_add_u32 s94, s37, s86
  s_add_u32 m0, s94, 0
  s_nop 0
  buffer_load_dwordx4 v32, s[8:11], s42 offen sc1 lds
  s_add_u32 m0, s94, 4096
  s_nop 0
  buffer_load_dwordx4 v33, s[8:11], s42 offen sc1 lds
  s_cmp_eq_u64 s[64:65], 0
  s_cbranch_scc1 Lsk_104
  s_add_u32 m0, s94, 8192
  s_mov_b64 exec, s[64:65]
  buffer_load_dwordx4 v34, s[8:11], s42 offen sc1 lds
  s_mov_b64 exec, -1
Lsk_104:
  s_add_u32 s69, s69, 1
  s_cmp_ge_u32 s69, 27
  s_cselect_b32 s69, 0, s69
  s_mul_i32 s42, s69, 128
  s_add_u32 s37, s37, 12288
  s_cmp_ge_u32 s37, 61440
  s_cselect_b32 s37, 0, s37
  s_add_u32 s95, s93, s86
  s_add_u32 m0, s95, 61440
  s_nop 0
  buffer_load_dwordx4 v35, s[12:15], s43 offen lds
  s_add_u32 m0, s95, 65536
  s_nop 0
  buffer_load_dwordx4 v36, s[12:15], s43 offen lds
  s_add_u32 s92, s92, 1
  s_cmp_ge_u32 s92, 27
  s_cselect_b32 s92, 0, s92
  s_mul_i32 s43, s92, 81920
  s_add_u32 s93, s93, 8192
  s_cmp_ge_u32 s93, 98304
  s_cselect_b32 s93, 0, s93
  s_waitcnt vmcnt(8)
  s_barrier
  s_add_u32 s94, s37, s86
  s_add_u32 m0, s94, 0
  s_nop 0
  buffer_load_dwordx4 v32, s[8:11], s42 offen sc1 lds
  s_add_u32 m0, s94, 4096
  s_nop 0
  buffer_load_dwordx4 v33, s[8:11], s42 offen sc1 lds
  s_cmp_eq_u64 s[64:65], 0
  s_cbranch_scc1 Lsk_105
  s_add_u32 m0, s94, 8192
  s_mov_b64 exec, s[64:65]
  buffer_load_dwordx4 v34, s[8:11], s42 offen sc1 lds
  s_mov_b64 exec, -1
Lsk_105:
  s_add_u32 s69, s69, 1
  s_cmp_ge_u32 s69, 27
  s_cselect_b32 s69, 0, s69
  s_mul_i32 s42, s69, 128
  s_add_u32 s37, s37, 12288
  s_cmp_ge_u32 s37, 61440
  s_cselect_b32 s37, 0, s37
  s_add_u32 s95, s93, s86
  s_add_u32 m0, s95, 61440
  s_nop 0
  buffer_load_dwordx4 v35, s[12:15], s43 offen lds
  s_add_u32 m0, s95, 65536
  s_nop 0
  buffer_load_dwordx4 v36, s[12:15], s43 offen lds
  s_add_u32 s92, s92, 1
  s_cmp_ge_u32 s92, 27
  s_cselect_b32 s92, 0, s92
  s_mul_i32 s43, s92, 81920
  s_add_u32 s93, s93, 8192
  s_cmp_ge_u32 s93, 98304
  s_cselect_b32 s93, 0, s93
  s_waitcnt vmcnt(10)
  s_barrier
  s_add_u32 s94, s37, s86
  s_add_u32 m0, s94, 0
  s_nop 0
  buffer_load_dwordx4 v32, s[8:11], s42 offen sc1 lds
  s_add_u32 m0, s94, 4096
  s_nop 0
  buffer_load_dwordx4 v33, s[8:11], s42 offen sc1 lds
  s_cmp_eq_u64 s[64:65], 0
  s_cbranch_scc1 Lsk_106
  s_add_u32 m0, s94, 8192
  s_mov_b64 exec, s[64:65]
  buffer_load_dwordx4 v34, s[8:11], s42 offen sc1 lds
  s_mov_b64 exec, -1
Lsk_106:
  s_add_u32 s69, s69, 1
  s_cmp_ge_u32 s69, 27
  s_cselect_b32 s69, 0, s69
  s_mul_i32 s42, s69, 128
  s_add_u32 s37, s37, 12288
  s_cmp_ge_u32 s37, 61440
  s_cselect_b32 s37, 0, s37
  s_add_u32 s95, s93, s86
  s_add_u32 m0, s95, 61440
  s_nop 0
  buffer_load_dwordx4 v35, s[12:15], s43 offen lds
  s_add_u32 m0, s95, 65536
  s_nop 0
  buffer_load_dwordx4 v36, s[12:15], s43 offen lds
  s_add_u32 s92, s92, 1
  s_cmp_ge_u32 s92, 27
  s_cselect_b32 s92, 0, s92
  s_mul_i32 s43, s92, 81920
  s_add_u32 s93, s93, 8192
  s_cmp_ge_u32 s93, 98304
  s_cselect_b32 s93, 0, s93
  s_waitcnt vmcnt(12)
  s_barrier
  s_mov_b32 s38, 12
Llmain_107:
  s_add_u32 s94, s37, s86
  s_add_u32 m0, s94, 0
  s_nop 0
  buffer_load_dwordx4 v32, s[8:11], s42 offen sc1 lds
  s_add_u32 m0, s94, 4096
  s_nop 0
  buffer_load_dwordx4 v33, s[8:11], s42 offen sc1 lds
  s_cmp_eq_u64 s[64:65], 0
  s_cbranch_scc1 Lsk_108
  s_add_u32 m0, s94, 8192
  s_mov_b64 exec, s[64:65]
  buffer_load_dwordx4 v34, s[8:11], s42 offen sc1 lds
  s_mov_b64 exec, -1
Lsk_108:
  s_add_u32 s69, s69, 1
  s_cmp_ge_u32 s69, 27
  s_cselect_b32 s69, 0, s69
  s_mul_i32 s42, s69, 128
  s_add_u32 s37, s37, 12288
  s_cmp_ge_u32 s37, 61440
  s_cselect_b32 s37, 0, s37
  s_add_u32 s95, s93, s86
  s_add_u32 m0, s95, 61440
  s_nop 0
  buffer_load_dwordx4 v35, s[12:15], s43 offen lds
  s_add_u32 m0, s95, 65536
  s_nop 0
  buffer_load_dwordx4 v36, s[12:15], s43 offen lds
  s_add_u32 s92, s92, 1
  s_cmp_ge_u32 s92, 27
  s_cselect_b32 s92, 0, s92
  s_mul_i32 s43, s92, 81920
  s_add_u32 s93, s93, 8192
  s_cmp_ge_u32 s93, 98304
  s_cselect_b32 s93, 0, s93
  s_waitcnt vmcnt(14)
  s_barrier
  s_sub_u32 s38, s38, 1
  s_cmp_lg_u32 s38, 0
  s_cbranch_scc1 Llmain_107
  s_add_u32 s94, s37, s86
  s_add_u32 m0, s94, 0
  s_nop 0
  buffer_load_dwordx4 v32, s[8:11], s42 offen sc1 lds
  s_add_u32 m0, s94, 4096
  s_nop 0
  buffer_load_dwordx4 v33, s[8:11], s42 offen sc1 lds
  s_cmp_eq_u64 s[64:65], 0
  s_cbranch_scc1 Lsk_109
  s_add_u32 m0, s94, 8192
  s_mov_b64 exec, s[64:65]
  buffer_load_dwordx4 v34, s[8:11], s42 offen sc1 lds
  s_mov_b64 exec, -1
Lsk_109:
  s_add_u32 s69, s69, 1
  s_cmp_ge_u32 s69, 27
  s_cselect_b32 s69, 0, s69
  s_mul_i32 s42, s69, 128
  s_add_u32 s37, s37, 12288
  s_cmp_ge_u32 s37, 61440
  s_cselect_b32 s37, 0, s37
  s_waitcnt vmcnt(12)
  s_barrier
  s_add_u32 s94, s37, s86
  s_add_u32 m0, s94, 0
  s_nop 0
  buffer_load_dwordx4 v32, s[8:11], s42 offen sc1 lds
  s_add_u32 m0, s94, 4096
  s_nop 0
  buffer_load_dwordx4 v33, s[8:11], s42 offen sc1 lds
  s_cmp_eq_u64 s[64:65], 0
  s_cbranch_scc1 Lsk_110
  s_add_u32 m0, s94, 8192
  s_mov_b64 exec, s[64:65]
  buffer_load_dwordx4 v34, s[8:11], s42 offen sc1 lds
  s_mov_b64 exec, -1
Lsk_110:
  s_add_u32 s69, s69, 1
  s_cmp_ge_u32 s69, 27
  s_cselect_b32 s69, 0, s69
  s_mul_i32 s42, s69, 128
  s_add_u32 s37, s37, 12288
  s_cmp_ge_u32 s37, 61440
  s_cselect_b32 s37, 0, s37
  s_waitcnt vmcnt(10)
  s_barrier
  s_add_u32 s94, s37, s86
  s_add_u32 m0, s94, 0
  s_nop 0
  buffer_load_dwordx4 v32, s[8:11], s42 offen sc1 lds
  s_add_u32 m0, s94, 4096
  s_nop 0
  buffer_load_dwordx4 v33, s[8:11], s42 offen sc1 lds
  s_cmp_eq_u64 s[64:65], 0
  s_cbranch_scc1 Lsk_111
  s_add_u32 m0, s94, 8192
  s_mov_b64 exec, s[64:65]
  buffer_load_dwordx4 v34, s[8:11], s42 offen sc1 lds
  s_mov_b64 exec, -1
Lsk_111:
  s_add_u32 s69, s69, 1
  s_cmp_ge_u32 s69, 27
  s_cselect_b32 s69, 0, s69
  s_mul_i32 s42, s69, 128
  s_add_u32 s37, s37, 12288
  s_cmp_ge_u32 s37, 61440
  s_cselect_b32 s37, 0, s37
  s_waitcnt vmcnt(8)
  s_barrier
  s_mov_b32 s38, 4
Llmain_112:
  s_add_u32 s94, s37, s86
  s_add_u32 m0, s94, 0
  s_nop 0
  buffer_load_dwordx4 v32, s[8:11], s42 offen sc1 lds
  s_add_u32 m0, s94, 4096
  s_nop 0
  buffer_load_dwordx4 v33, s[8:11], s42 offen sc1 lds
  s_cmp_eq_u64 s[64:65], 0
  s_cbranch_scc1 Lsk_113
  s_add_u32 m0, s94, 8192
  s_mov_b64 exec, s[64:65]
  buffer_load_dwordx4 v34, s[8:11], s42 offen sc1 lds
  s_mov_b64 exec, -1
Lsk_113:
  s_add_u32 s69, s69, 1
  s_cmp_ge_u32 s69, 27
  s_cselect_b32 s69, 0, s69
  s_mul_i32 s42, s69, 128
  s_add_u32 s37, s37, 12288
  s_cmp_ge_u32 s37, 61440
  s_cselect_b32 s37, 0, s37
  s_waitcnt vmcnt(6)
  s_barrier
  s_sub_u32 s38, s38, 1
  s_cmp_lg_u32 s38, 0
  s_cbranch_scc1 Llmain_112
  s_waitcnt vmcnt(4)
  s_barrier
  s_waitcnt vmcnt(2)
  s_barrier
  s_waitcnt vmcnt(0)
  s_barrier
  s_barrier
  ds_read_b128 v[16:19], v108 offset:0
  ds_read_b128 v[20:23], v108 offset:8192
  s_waitcnt vmcnt(0) lgkmcnt(0)
  v_lshlrev_b32 v28, 16, v16
  v_and_b32 v29, 0xffff0000, v16
  v_lshlrev_b32 v30, 16, v100
  v_and_b32 v31, 0xffff0000, v100
  v_pk_add_f32 v[28:29], v[28:29], v[30:31]
  v_cvt_pk_bf16_f32 v16, v28, v29
  v_lshlrev_b32 v28, 16, v17
  v_and_b32 v29, 0xffff0000, v17
  v_lshlrev_b32 v30, 16, v101
  v_and_b32 v31, 0xffff0000, v101
  v_pk_add_f32 v[28:29], v[28:29], v[30:31]
  v_cvt_pk_bf16_f32 v17, v28, v29
  v_lshlrev_b32 v28, 16, v18
  v_and_b32 v29, 0xffff0000, v18
  v_lshlrev_b32 v30, 16, v102
  v_and_b32 v31, 0xffff0000, v102
  v_pk_add_f32 v[28:29], v[28:29], v[30:31]
  v_cvt_pk_bf16_f32 v18, v28, v29
  v_lshlrev_b32 v28, 16, v19
  v_and_b32 v29, 0xffff0000, v19
  v_lshlrev_b32 v30, 16, v103
  v_and_b32 v31, 0xffff0000, v103
  v_pk_add_f32 v[28:29], v[28:29], v[30:31]
  v_cvt_pk_bf16_f32 v19, v28, v29
  buffer_store_dwordx4 v[16:19], v109, s[20:23], 0 offen sc0 sc1
  s_cmp_ge_u32 s36, 3
  s_cbranch_scc1 Lsdone_114
  v_lshlrev_b32 v28, 16, v20
  v_and_b32 v29, 0xffff0000, v20
  v_lshlrev_b32 v30, 16, v104
  v_and_b32 v31, 0xffff0000, v104
  v_pk_add_f32 v[28:29], v[28:29], v[30:31]
  v_cvt_pk_bf16_f32 v20, v28, v29
  v_lshlrev_b32 v28, 16, v21
  v_and_b32 v29, 0xffff0000, v21
  v_lshlrev_b32 v30, 16, v105
  v_and_b32 v31, 0xffff0000, v105
  v_pk_add_f32 v[28:29], v[28:29], v[30:31]
  v_cvt_pk_bf16_f32 v21, v28, v29
  v_lshlrev_b32 v28, 16, v22
  v_and_b32 v29, 0xffff0000, v22
  v_lshlrev_b32 v30, 16, v106
  v_and_b32 v31, 0xffff0000, v106
  v_pk_add_f32 v[28:29], v[28:29], v[30:31]
  v_cvt_pk_bf16_f32 v22, v28, v29
  v_lshlrev_b32 v28, 16, v23
  v_and_b32 v29, 0xffff0000, v23
  v_lshlrev_b32 v30, 16, v107
  v_and_b32 v31, 0xffff0000, v107
  v_pk_add_f32 v[28:29], v[28:29], v[30:31]
  v_cvt_pk_bf16_f32 v23, v28, v29
  buffer_store_dwordx4 v[20:23], v110, s[20:23], 0 offen sc0 sc1
Lsdone_114:
  s_mov_b32 s85, -1
Linv_95:
  s_waitcnt vmcnt(0)
L_exit:
  s_endpgm
.section .rodata,"a"
.p2align 6
.amdhsa_kernel sequential_preLN__sliding_local_dilated__glu_gated_bilinear__prompt_kernel
  .amdhsa_next_free_vgpr 256
  .amdhsa_next_free_sgpr 102
  .amdhsa_accum_offset 160
  .amdhsa_group_segment_fixed_size 0
  .amdhsa_kernarg_size 80
  .amdhsa_user_sgpr_count 2
  .amdhsa_user_sgpr_kernarg_segment_ptr 1
  .amdhsa_system_sgpr_workgroup_id_x 1
  .amdhsa_float_denorm_mode_32 3
.end_amdhsa_kernel
```
